```python
import torch

def _softmax(x, axis=-1):
    return torch.softmax(x, dim=axis)

def _gelu(x):
    return torch.nn.functional.gelu(x, approximate='tanh')

def _silu(x):
    return torch.nn.functional.silu(x)

def _sigmoid(x):
    return torch.sigmoid(x)

def _layernorm(x, axis=-1, eps=1e-05):
    m = x.mean(dim=axis, keepdim=True)
    v = x.var(dim=axis, keepdim=True, unbiased=False)
    return (x - m) / torch.sqrt(v + eps)

def _scatter_add(tgt, idx, src, axis=0):
    return tgt.clone().index_add_(axis, idx, src)

def _segment_sum(src, seg, n):
    out = torch.zeros((n,) + src.shape[1:], dtype=src.dtype)
    return out.index_add_(0, seg, src)

def _pad(x, pw):
    flat = tuple((v for pair in reversed(pw) for v in pair))
    return torch.nn.functional.pad(x, flat)
kernel_name = 'adaLN_cond__compressed_kv_cla__glu_gated_glu__decode'

def setup_inputs():

    _w = lambda a: (lambda t: t.to(torch.bfloat16) if t.is_floating_point() else t)(torch.as_tensor(a))

    def _A_setup():
        B, H, Sq, Sk, D, M = (4, 32, 1, 4096, 128, 512)
        Dc = 4 * D
        return {'x': _w((lambda *s: torch.randn(*s, dtype=torch.bfloat16) * 0.05)(B, Sq, M)), 'c_kv': _w((lambda *s: torch.randn(*s, dtype=torch.bfloat16) * 1.6)(B, Sk, Dc)), 'w_q': _w((lambda *s: torch.randn(*s, dtype=torch.bfloat16) * 1.6)(M, H, D) * M ** (-0.5)), 'w_uk': _w((lambda *s: torch.randn(*s, dtype=torch.bfloat16) * 1.6)(Dc, H, D) * Dc ** (-0.5)), 'w_uv': _w((lambda *s: torch.randn(*s, dtype=torch.bfloat16) * 1.6)(Dc, H, D) * Dc ** (-0.5)), 'w_o': _w((lambda *s: torch.randn(*s, dtype=torch.bfloat16) * 1.6)(H, D, M) * (H * D) ** (-0.5))}
    _A_in = _A_setup()

    def _B_setup():
        B, S, D, F = (4, 1, 512, 1792)
        return {'x': _w((lambda *s: torch.randn(*s, dtype=torch.bfloat16) * 0.05)(B, S, D)), 'w_gate': _w((lambda *s: torch.randn(*s, dtype=torch.bfloat16) * 0.1)(D, F)), 'w_up': _w((lambda *s: torch.randn(*s, dtype=torch.bfloat16) * 0.05)(D, F)), 'w_down': _w((lambda *s: torch.randn(*s, dtype=torch.bfloat16) * 0.05)(F, D))}
    _B_in = _B_setup()
    return {'A_x': _A_in['x'], 'A_c_kv': _A_in['c_kv'], 'A_w_q': _A_in['w_q'], 'A_w_uk': _A_in['w_uk'], 'A_w_uv': _A_in['w_uv'], 'A_w_o': _A_in['w_o'], 'B_x': _B_in['x'], 'B_w_gate': _B_in['w_gate'], 'B_w_up': _B_in['w_up'], 'B_w_down': _B_in['w_down'], 'c': _w((lambda *s: torch.randn(*s, dtype=torch.bfloat16) * 0.2)(4, 512) * 8.0), 'w_mod': _w((lambda *s: torch.randn(*s, dtype=torch.bfloat16) * 0.2)(512, 6 * 512) * 512 ** (-0.5) * 8.0)}

def reference(A_x, A_c_kv, A_w_q, A_w_uk, A_w_uv, A_w_o, B_x, B_w_gate, B_w_up, B_w_down, c, w_mod):

    def _A_ref(x, c_kv, w_q, w_uk, w_uv, w_o):
        B, Sq, M = (x.shape[0], x.shape[1], x.shape[2])
        Sk = c_kv.shape[1]
        H, D = (w_q.shape[1], w_q.shape[2])
        q = torch.einsum('bqm,mhd->bhqd', x, w_q)
        k = torch.einsum('bkc,chd->bhkd', c_kv, w_uk)
        v = torch.einsum('bkc,chd->bhkd', c_kv, w_uv)
        scores = torch.einsum('bhqd,bhkd->bhqk', q, k) * D ** (-0.5)
        off = Sk - Sq
        qi = torch.arange(Sq)[:, None]
        kj = torch.arange(Sk)[None, :]
        cmask = kj <= qi + off
        scores = torch.where(cmask[None, None], scores, -1000000000.0)
        p = _softmax(scores, axis=-1)
        ctx = torch.einsum('bhqk,bhkd->bhqd', p, v)
        return torch.einsum('bhqd,hdm->bqm', ctx, w_o)

    def _B_ref(x, w_gate, w_up, w_down):
        g = torch.einsum('bsd,df->bsf', x, w_gate)
        u = torch.einsum('bsd,df->bsf', x, w_up)
        h = _sigmoid(g) * u
        return torch.einsum('bsf,fd->bsd', h, w_down)
    x = A_x
    mod = (_silu(c) @ w_mod).reshape(c.shape[0], 6, 1, -1)
    sa, ca, ga, sb, cb, gb = (mod[:, 0].clone(), mod[:, 1].clone(), mod[:, 2].clone(), mod[:, 3].clone(), mod[:, 4].clone(), mod[:, 5].clone())
    h = _layernorm(x, axis=-1) * (1 + ca) + sa
    x = x + ga * _A_ref(h, A_c_kv, A_w_q, A_w_uk, A_w_uv, A_w_o)
    h = _layernorm(x, axis=-1) * (1 + cb) + sb
    x = x + gb * _B_ref(h, B_w_gate, B_w_up, B_w_down)
    return x
```

```asm
; @launch grid=(256,1,1) block=(320,1,1) lds=163840
.amdgcn_target "amdgcn-amd-amdhsa--gfx950"
.text
.globl adaLN_cond__compressed_kv_cla__glu_gated_glu__decode_kernel
.p2align 8
.type adaLN_cond__compressed_kv_cla__glu_gated_glu__decode_kernel,@function
adaLN_cond__compressed_kv_cla__glu_gated_glu__decode_kernel:
L_beg:
    s_cmp_ge_u32 s2, 256
    s_cbranch_scc1 L_end
    s_load_dwordx8 s[24:31], s[0:1], 64
    s_load_dwordx16 s[8:23], s[0:1], 0
    s_load_dwordx2 s[4:5], s[0:1], 112
    s_load_dwordx2 s[32:33], s[0:1], 96
    s_lshr_b32 s62, s2, 3
    v_lshrrev_b32 v3, 6, v0
    v_and_b32 v1, 63, v0
    s_and_b32 s61, s2, 7
    v_readfirstlane_b32 s60, v3
    v_lshlrev_b32 v2, 4, v1
    s_mov_b32 s38, 0x1000000
    s_mov_b32 s39, 0x20000
    s_mov_b64 s[42:43], s[38:39]
    s_mov_b64 s[46:47], s[38:39]
    s_mov_b32 s6, 0x10000000
    s_mov_b32 s7, s39
    s_mov_b32 s64, 0
    s_cmp_lt_u32 s62, 16
    s_cbranch_scc1 L_F
    s_cmp_lg_u32 s60, 4
    s_cbranch_scc1 L_A2
    s_getpc_b64 s[100:101]
L_pc:
    s_sub_u32 s100, s100, L_pc-L_beg
    s_subb_u32 s101, s101, 0
    s_and_b32 s99, s62, 15
    s_lshl_b32 s99, s99, 11
    s_mov_b64 exec, 0xffff
    v_lshl_add_u32 v4, v1, 7, s99
    v_cmp_gt_u32 vcc, L_end-L_beg, v4
    s_nop 0
    s_and_b64 exec, exec, vcc
    s_cbranch_execz L_npf
    global_load_dword v5, v4, s[100:101]
L_npf:
    s_mov_b64 exec, -1
    s_sub_u32 s62, s62, 16
    s_cmp_ge_u32 s61, 4
    s_cbranch_scc1 L_AH2
    v_and_b32 v13, 3, v1
    v_lshrrev_b32 v11, 4, v1
    v_bfe_u32 v14, v1, 2, 2
    v_and_b32 v15, 15, v1
    v_lshlrev_b32 v15, 4, v15
    v_lshl_add_u32 v15, v11, 10, v15
    v_lshrrev_b32 v10, 2, v1
    v_mul_u32_u24 v10, 6144, v10
    v_lshl_add_u32 v10, v13, 4, v10
    s_mul_i32 s3, s61, 786432
    s_lshl_b32 s57, s62, 6
    s_add_u32 s3, s3, s57
    s_lshl_b32 s69, s61, 8
    s_waitcnt lgkmcnt(0)
    s_mov_b64 s[36:37], s[28:29]
    buffer_load_dwordx4 v[16:19], v15, s[36:39], s69 offen
    s_mov_b64 s[44:45], s[30:31]
    s_mov_b64 s[40:41], s[8:9]
    buffer_load_dwordx4 v[32:35], v15, s[40:43], 0 offen offset:0
    buffer_load_dwordx4 v[36:39], v15, s[40:43], 0 offen offset:256
    buffer_load_dwordx4 v[40:43], v15, s[40:43], 0 offen offset:512
    buffer_load_dwordx4 v[44:47], v15, s[40:43], 0 offen offset:768
    s_mov_b32 m0, 4096
    s_nop 0
    buffer_load_dwordx4 v10, s[44:47], s3 offen offset:0 nt lds
    s_mov_b32 m0, 11264
    s_nop 0
    buffer_load_dwordx4 v10, s[44:47], s3 offen offset:1024 nt lds
    s_mov_b32 m0, 5120
    s_add_u32 s3, s3, 98304
    buffer_load_dwordx4 v10, s[44:47], s3 offen offset:0 nt lds
    s_mov_b32 m0, 12288
    s_nop 0
    buffer_load_dwordx4 v10, s[44:47], s3 offen offset:1024 nt lds
    s_mov_b32 m0, 6144
    s_add_u32 s3, s3, 98304
    buffer_load_dwordx4 v10, s[44:47], s3 offen offset:0 nt lds
    s_mov_b32 m0, 13312
    s_nop 0
    buffer_load_dwordx4 v10, s[44:47], s3 offen offset:1024 nt lds
    s_mov_b32 m0, 7168
    s_add_u32 s3, s3, 98304
    buffer_load_dwordx4 v10, s[44:47], s3 offen offset:0 nt lds
    s_mov_b32 m0, 14336
    s_nop 0
    buffer_load_dwordx4 v10, s[44:47], s3 offen offset:1024 nt lds
    s_mov_b32 m0, 8192
    s_add_u32 s3, s3, 98304
    buffer_load_dwordx4 v10, s[44:47], s3 offen offset:0 nt lds
    s_mov_b32 m0, 15360
    s_nop 0
    buffer_load_dwordx4 v10, s[44:47], s3 offen offset:1024 nt lds
    s_mov_b32 m0, 9216
    s_add_u32 s3, s3, 98304
    buffer_load_dwordx4 v10, s[44:47], s3 offen offset:0 nt lds
    s_mov_b32 m0, 16384
    s_nop 0
    buffer_load_dwordx4 v10, s[44:47], s3 offen offset:1024 nt lds
    s_mov_b32 m0, 10240
    s_add_u32 s3, s3, 98304
    buffer_load_dwordx4 v10, s[44:47], s3 offen offset:0 nt lds
    s_mov_b32 m0, 17408
    s_nop 0
    buffer_load_dwordx4 v10, s[44:47], s3 offen offset:1024 nt lds
    s_mov_b32 m0, 11264
    s_add_u32 s3, s3, 98304
    buffer_load_dwordx4 v10, s[44:47], s3 offen offset:0 nt lds
    s_mov_b32 m0, 18432
    s_nop 0
    buffer_load_dwordx4 v10, s[44:47], s3 offen offset:1024 nt lds
    v_lshlrev_b32 v12, 4, v11
    v_lshl_add_u32 v12, v13, 10, v12
    buffer_load_dwordx4 v[48:51], v12, s[40:43], s57 offen
    s_load_dword s63, s[4:5], 0
    s_getreg_b32 s65, hwreg(HW_REG_XCC_ID, 0, 4)
    s_lshl_b32 s3, s61, 4
    s_add_u32 s3, s3, s62
    s_lshl_b32 s3, s3, 7
    s_add_u32 s3, s3, 0x18000
    v_lshlrev_b32 v20, 4, v11
    v_lshl_add_u32 v20, v13, 8, v20
    s_waitcnt vmcnt(21)
    v_lshlrev_b32 v68, 16, v16
    v_and_b32 v69, 0xffff0000, v16
    v_lshlrev_b32 v70, 16, v17
    v_and_b32 v71, 0xffff0000, v17
    v_lshlrev_b32 v72, 16, v18
    v_and_b32 v73, 0xffff0000, v18
    v_lshlrev_b32 v74, 16, v19
    v_and_b32 v75, 0xffff0000, v19
    v_mul_f32 v76, 0xbfb8aa3b, v68
    v_mul_f32 v77, 0xbfb8aa3b, v69
    v_mul_f32 v78, 0xbfb8aa3b, v70
    v_mul_f32 v79, 0xbfb8aa3b, v71
    v_mul_f32 v80, 0xbfb8aa3b, v72
    v_mul_f32 v81, 0xbfb8aa3b, v73
    v_mul_f32 v82, 0xbfb8aa3b, v74
    v_mul_f32 v83, 0xbfb8aa3b, v75
    v_exp_f32 v76, v76
    v_exp_f32 v77, v77
    v_exp_f32 v78, v78
    v_exp_f32 v79, v79
    v_exp_f32 v80, v80
    v_exp_f32 v81, v81
    v_exp_f32 v82, v82
    v_exp_f32 v83, v83
    v_add_f32 v76, 1.0, v76
    v_add_f32 v77, 1.0, v77
    v_add_f32 v78, 1.0, v78
    v_add_f32 v79, 1.0, v79
    v_add_f32 v80, 1.0, v80
    v_add_f32 v81, 1.0, v81
    v_add_f32 v82, 1.0, v82
    v_add_f32 v83, 1.0, v83
    v_rcp_f32 v76, v76
    v_rcp_f32 v77, v77
    v_rcp_f32 v78, v78
    v_rcp_f32 v79, v79
    v_rcp_f32 v80, v80
    v_rcp_f32 v81, v81
    v_rcp_f32 v82, v82
    v_rcp_f32 v83, v83
    v_mul_f32 v68, v68, v76
    v_mul_f32 v69, v69, v77
    v_mul_f32 v70, v70, v78
    v_mul_f32 v71, v71, v79
    v_mul_f32 v72, v72, v80
    v_mul_f32 v73, v73, v81
    v_mul_f32 v74, v74, v82
    v_mul_f32 v75, v75, v83
    v_cvt_pk_bf16_f32 v52, v68, v69
    v_cvt_pk_bf16_f32 v53, v70, v71
    v_cvt_pk_bf16_f32 v54, v72, v73
    v_cvt_pk_bf16_f32 v55, v74, v75
    ds_write_b128 v2, v[52:55]
    s_waitcnt lgkmcnt(0)
    s_mul_i32 s63, s63, 0x9E3779B1
    s_add_u32 s63, s63, 0x7F4A7C15
    ds_read_b128 v[52:55], v20 offset:0
    ds_read_b128 v[56:59], v20 offset:64
    ds_read_b128 v[60:63], v20 offset:128
    ds_read_b128 v[64:67], v20 offset:192
    v_mov_b32 v6, s63
    v_mov_b32 v7, s65
    s_mov_b64 exec, 1
    buffer_store_dwordx2 v[6:7], v2, s[4:7], s3 offen sc1
    s_mov_b64 exec, -1
    s_waitcnt vmcnt(18)
    v_lshlrev_b32 v68, 16, v32
    v_and_b32 v69, 0xffff0000, v32
    v_lshlrev_b32 v70, 16, v33
    v_and_b32 v71, 0xffff0000, v33
    v_lshlrev_b32 v72, 16, v34
    v_and_b32 v73, 0xffff0000, v34
    v_lshlrev_b32 v74, 16, v35
    v_and_b32 v75, 0xffff0000, v35
    v_pk_mul_f32 v[86:87], v[68:69], v[68:69]
    v_pk_add_f32 v[84:85], v[68:69], v[70:71]
    v_pk_fma_f32 v[86:87], v[70:71], v[70:71], v[86:87]
    v_pk_fma_f32 v[86:87], v[72:73], v[72:73], v[86:87]
    v_pk_add_f32 v[84:85], v[84:85], v[72:73]
    v_pk_fma_f32 v[86:87], v[74:75], v[74:75], v[86:87]
    v_pk_add_f32 v[84:85], v[84:85], v[74:75]
    v_lshlrev_b32 v68, 16, v36
    v_and_b32 v69, 0xffff0000, v36
    v_lshlrev_b32 v70, 16, v37
    v_and_b32 v71, 0xffff0000, v37
    v_lshlrev_b32 v72, 16, v38
    v_and_b32 v73, 0xffff0000, v38
    v_lshlrev_b32 v74, 16, v39
    v_and_b32 v75, 0xffff0000, v39
    v_pk_fma_f32 v[86:87], v[68:69], v[68:69], v[86:87]
    v_pk_add_f32 v[84:85], v[84:85], v[68:69]
    v_pk_fma_f32 v[86:87], v[70:71], v[70:71], v[86:87]
    v_pk_add_f32 v[84:85], v[84:85], v[70:71]
    v_pk_fma_f32 v[86:87], v[72:73], v[72:73], v[86:87]
    v_pk_add_f32 v[84:85], v[84:85], v[72:73]
    v_pk_fma_f32 v[86:87], v[74:75], v[74:75], v[86:87]
    v_pk_add_f32 v[84:85], v[84:85], v[74:75]
    v_lshlrev_b32 v68, 16, v40
    v_and_b32 v69, 0xffff0000, v40
    v_lshlrev_b32 v70, 16, v41
    v_and_b32 v71, 0xffff0000, v41
    v_lshlrev_b32 v72, 16, v42
    v_and_b32 v73, 0xffff0000, v42
    v_lshlrev_b32 v74, 16, v43
    v_and_b32 v75, 0xffff0000, v43
    v_pk_fma_f32 v[86:87], v[68:69], v[68:69], v[86:87]
    v_pk_add_f32 v[84:85], v[84:85], v[68:69]
    v_pk_fma_f32 v[86:87], v[70:71], v[70:71], v[86:87]
    v_pk_add_f32 v[84:85], v[84:85], v[70:71]
    v_pk_fma_f32 v[86:87], v[72:73], v[72:73], v[86:87]
    v_pk_add_f32 v[84:85], v[84:85], v[72:73]
    v_pk_fma_f32 v[86:87], v[74:75], v[74:75], v[86:87]
    v_pk_add_f32 v[84:85], v[84:85], v[74:75]
    v_lshlrev_b32 v68, 16, v44
    v_and_b32 v69, 0xffff0000, v44
    v_lshlrev_b32 v70, 16, v45
    v_and_b32 v71, 0xffff0000, v45
    v_lshlrev_b32 v72, 16, v46
    v_and_b32 v73, 0xffff0000, v46
    v_lshlrev_b32 v74, 16, v47
    v_and_b32 v75, 0xffff0000, v47
    v_pk_fma_f32 v[86:87], v[68:69], v[68:69], v[86:87]
    v_pk_add_f32 v[84:85], v[84:85], v[68:69]
    v_pk_fma_f32 v[86:87], v[70:71], v[70:71], v[86:87]
    v_pk_add_f32 v[84:85], v[84:85], v[70:71]
    v_pk_fma_f32 v[86:87], v[72:73], v[72:73], v[86:87]
    v_pk_add_f32 v[84:85], v[84:85], v[72:73]
    v_pk_fma_f32 v[86:87], v[74:75], v[74:75], v[86:87]
    v_pk_add_f32 v[84:85], v[84:85], v[74:75]
    v_add_f32 v84, v84, v85
    v_add_f32 v85, v86, v87
    s_nop 0
    v_add_f32_dpp v84, v84, v84 row_ror:1 row_mask:0xf bank_mask:0xf
    v_add_f32_dpp v85, v85, v85 row_ror:1 row_mask:0xf bank_mask:0xf
    s_nop 0
    v_add_f32_dpp v84, v84, v84 row_ror:2 row_mask:0xf bank_mask:0xf
    v_add_f32_dpp v85, v85, v85 row_ror:2 row_mask:0xf bank_mask:0xf
    s_nop 0
    v_add_f32_dpp v84, v84, v84 row_ror:4 row_mask:0xf bank_mask:0xf
    v_add_f32_dpp v85, v85, v85 row_ror:4 row_mask:0xf bank_mask:0xf
    s_nop 0
    v_add_f32_dpp v84, v84, v84 row_ror:8 row_mask:0xf bank_mask:0xf
    v_add_f32_dpp v85, v85, v85 row_ror:8 row_mask:0xf bank_mask:0xf
    v_lshlrev_b32 v86, 6, v13
    ds_bpermute_b32 v84, v86, v84
    ds_bpermute_b32 v85, v86, v85
    s_waitcnt lgkmcnt(0)
    v_mul_f32 v84, 0x3b000000, v84
    v_mul_f32 v85, 0x3b000000, v85
    v_fma_f32 v85, -v84, v84, v85
    v_max_f32 v85, 0, v85
    v_add_f32 v85, 0x3727c5ac, v85
    v_rsq_f32 v86, v85
    v_lshl_add_u32 v10, v11, 3, v14
    v_lshlrev_b32 v10, 6, v10
    v_lshl_add_u32 v10, v13, 4, v10
    v_lshlrev_b32 v12, 4, v13
    v_lshl_add_u32 v12, v11, 6, v12
    v_bfe_u32 v88, v1, 2, 1
    v_cmp_eq_u32 vcc, 0, v88
    v_lshl_add_u32 v88, v88, 8, v12
    v_mov_b32 v89, s63
    s_cmp_eq_u32 s61, 0
    s_cselect_b32 s52, 1.0, 0
    s_mov_b32 s53, 0
    s_lshl_b32 s3, s62, 11
    s_lshl_b32 s69, s61, 9
    s_add_u32 s3, s3, s69
    s_add_u32 s3, s3, 0x2000
    s_waitcnt vmcnt(1)
    ds_read_b64_tr_b16 v[128:129], v10 offset:4096
    ds_read_b64_tr_b16 v[130:131], v10 offset:4352
    ds_read_b64_tr_b16 v[144:145], v10 offset:4104
    ds_read_b64_tr_b16 v[146:147], v10 offset:4360
    ds_read_b64_tr_b16 v[160:161], v10 offset:12288
    ds_read_b64_tr_b16 v[162:163], v10 offset:12544
    ds_read_b64_tr_b16 v[176:177], v10 offset:12296
    ds_read_b64_tr_b16 v[178:179], v10 offset:12552
    ds_read_b64_tr_b16 v[132:133], v10 offset:6144
    ds_read_b64_tr_b16 v[134:135], v10 offset:6400
    ds_read_b64_tr_b16 v[148:149], v10 offset:6152
    ds_read_b64_tr_b16 v[150:151], v10 offset:6408
    ds_read_b64_tr_b16 v[164:165], v10 offset:14336
    ds_read_b64_tr_b16 v[166:167], v10 offset:14592
    ds_read_b64_tr_b16 v[180:181], v10 offset:14344
    ds_read_b64_tr_b16 v[182:183], v10 offset:14600
    ds_read_b64_tr_b16 v[136:137], v10 offset:8192
    ds_read_b64_tr_b16 v[138:139], v10 offset:8448
    ds_read_b64_tr_b16 v[152:153], v10 offset:8200
    ds_read_b64_tr_b16 v[154:155], v10 offset:8456
    ds_read_b64_tr_b16 v[168:169], v10 offset:16384
    ds_read_b64_tr_b16 v[170:171], v10 offset:16640
    ds_read_b64_tr_b16 v[184:185], v10 offset:16392
    ds_read_b64_tr_b16 v[186:187], v10 offset:16648
    ds_read_b64_tr_b16 v[140:141], v10 offset:10240
    ds_read_b64_tr_b16 v[142:143], v10 offset:10496
    ds_read_b64_tr_b16 v[156:157], v10 offset:10248
    ds_read_b64_tr_b16 v[158:159], v10 offset:10504
    ds_read_b64_tr_b16 v[172:173], v10 offset:18432
    ds_read_b64_tr_b16 v[174:175], v10 offset:18688
    ds_read_b64_tr_b16 v[188:189], v10 offset:18440
    ds_read_b64_tr_b16 v[190:191], v10 offset:18696
    v_lshlrev_b32 v68, 16, v48
    v_and_b32 v69, 0xffff0000, v48
    v_lshlrev_b32 v70, 16, v49
    v_and_b32 v71, 0xffff0000, v49
    v_lshlrev_b32 v72, 16, v50
    v_and_b32 v73, 0xffff0000, v50
    v_lshlrev_b32 v74, 16, v51
    v_and_b32 v75, 0xffff0000, v51
    v_sub_f32 v68, v68, v84
    v_sub_f32 v69, v69, v84
    v_sub_f32 v70, v70, v84
    v_sub_f32 v71, v71, v84
    v_sub_f32 v72, v72, v84
    v_sub_f32 v73, v73, v84
    v_sub_f32 v74, v74, v84
    v_sub_f32 v75, v75, v84
    v_mul_f32 v68, v68, v86
    v_mul_f32 v69, v69, v86
    v_mul_f32 v70, v70, v86
    v_mul_f32 v71, v71, v86
    v_mul_f32 v72, v72, v86
    v_mul_f32 v73, v73, v86
    v_mul_f32 v74, v74, v86
    v_mul_f32 v75, v75, v86
    s_waitcnt lgkmcnt(15)
    v_mfma_f32_16x16x32_bf16 v[96:99], v[128:131], v[52:55], 0
    v_mfma_f32_16x16x32_bf16 v[100:103], v[144:147], v[52:55], 0
    v_mfma_f32_16x16x32_bf16 v[104:107], v[160:163], v[52:55], 0
    v_mfma_f32_16x16x32_bf16 v[108:111], v[176:179], v[52:55], 0
    s_waitcnt lgkmcnt(15)
    v_mfma_f32_16x16x32_bf16 v[96:99], v[132:135], v[56:59], v[96:99]
    v_mfma_f32_16x16x32_bf16 v[100:103], v[148:151], v[56:59], v[100:103]
    v_mfma_f32_16x16x32_bf16 v[104:107], v[164:167], v[56:59], v[104:107]
    v_mfma_f32_16x16x32_bf16 v[108:111], v[180:183], v[56:59], v[108:111]
    s_waitcnt lgkmcnt(8)
    v_mfma_f32_16x16x32_bf16 v[96:99], v[136:139], v[60:63], v[96:99]
    v_mfma_f32_16x16x32_bf16 v[100:103], v[152:155], v[60:63], v[100:103]
    v_mfma_f32_16x16x32_bf16 v[104:107], v[168:171], v[60:63], v[104:107]
    v_mfma_f32_16x16x32_bf16 v[108:111], v[184:187], v[60:63], v[108:111]
    s_waitcnt lgkmcnt(0)
    v_mfma_f32_16x16x32_bf16 v[96:99], v[140:143], v[64:67], v[96:99]
    v_mfma_f32_16x16x32_bf16 v[100:103], v[156:159], v[64:67], v[100:103]
    v_mfma_f32_16x16x32_bf16 v[104:107], v[172:175], v[64:67], v[104:107]
    v_mfma_f32_16x16x32_bf16 v[108:111], v[188:191], v[64:67], v[108:111]
    s_nop 6
    v_add_f32 v104, s52, v104
    v_add_f32 v105, s52, v105
    v_add_f32 v106, s52, v106
    v_add_f32 v107, s52, v107
    v_add_f32 v108, s52, v108
    v_add_f32 v109, s52, v109
    v_add_f32 v110, s52, v110
    v_add_f32 v111, s52, v111
    v_pk_fma_f32 v[96:97], v[68:69], v[104:105], v[96:97]
    v_pk_fma_f32 v[98:99], v[70:71], v[106:107], v[98:99]
    v_pk_fma_f32 v[100:101], v[72:73], v[108:109], v[100:101]
    v_pk_fma_f32 v[102:103], v[74:75], v[110:111], v[102:103]
    v_cvt_pk_bf16_f32 v76, v96, v97
    v_cvt_pk_bf16_f32 v77, v98, v99
    v_cvt_pk_bf16_f32 v78, v100, v101
    v_cvt_pk_bf16_f32 v79, v102, v103
    v_mov_b32 v80, v78
    v_cndmask_b32 v81, v79, v89, vcc
    v_cndmask_b32 v82, v89, v76, vcc
    v_mov_b32 v83, v77
    s_mov_b32 exec_lo, 0xff00ff
    s_mov_b32 exec_hi, 0xff00ff
    s_cmp_eq_u32 s53, 0
    s_cbranch_scc1 G_1
    buffer_store_dwordx4 v[80:83], v88, s[4:7], s3 offen
    s_branch G_2
G_1:
    buffer_store_dwordx4 v[80:83], v88, s[4:7], s3 offen sc1
G_2:
    s_mov_b64 exec, -1
    s_barrier
    s_endpgm
L_AH2:
    s_waitcnt lgkmcnt(0)
    s_load_dword s63, s[4:5], 0
    s_getreg_b32 s65, hwreg(HW_REG_XCC_ID, 0, 4)
    s_lshl_b32 s3, s61, 4
    s_add_u32 s3, s3, s62
    s_lshl_b32 s3, s3, 7
    s_add_u32 s3, s3, 0x18000
    s_waitcnt lgkmcnt(0)
    s_mul_i32 s63, s63, 0x9E3779B1
    s_add_u32 s63, s63, 0x7F4A7C15
    v_mov_b32 v6, s63
    v_mov_b32 v7, s65
    s_mov_b64 exec, 1
    buffer_store_dwordx2 v[6:7], v2, s[4:7], s3 offen sc1
    s_endpgm
L_A2:
    s_sub_u32 s62, s62, 16
    s_lshl_b32 s66, s61, 4
    s_add_u32 s66, s66, s62
    s_waitcnt lgkmcnt(0)
    s_load_dword s63, s[4:5], 0
    s_waitcnt lgkmcnt(0)
    s_lshl_b32 s67, s66, 17
    s_lshl_b32 s68, s60, 15
    s_add_u32 s67, s67, s68
    s_add_u32 s68, s68, 32768
    s_mov_b64 s[36:37], s[10:11]
    s_add_u32 m0, s68, 0
    s_nop 0
    buffer_load_dwordx4 v2, s[36:39], s67 offen offset:0 nt lds
    s_waitcnt lgkmcnt(0)
    s_mul_i32 s63, s63, 0x9E3779B1
    s_add_u32 s63, s63, 0x7F4A7C15
    s_cmp_ge_u32 s61, 4
    s_cselect_b64 vcc, -1, 0
    s_waitcnt vmcnt(0)
    v_xor_b32 v3, 64, v2
    buffer_load_dwordx4 v3, s[36:39], s67 offen offset:1024 nt lds
    s_cbranch_vccnz W_3
    s_barrier
W_3:
    s_cbranch_vccz W_4
    s_waitcnt vmcnt(0)
W_4:
    v_xor_b32 v3, 128, v2
    buffer_load_dwordx4 v3, s[36:39], s67 offen offset:2048 nt lds
    s_cbranch_vccz W_5
    s_waitcnt vmcnt(0)
W_5:
    v_xor_b32 v3, 192, v2
    buffer_load_dwordx4 v3, s[36:39], s67 offen offset:3072 nt lds
    s_add_u32 m0, s68, 4096
    s_add_u32 s67, s67, 4096
    v_xor_b32 v3, 16, v2
    buffer_load_dwordx4 v3, s[36:39], s67 offen offset:0 nt lds
    v_xor_b32 v3, 80, v2
    buffer_load_dwordx4 v3, s[36:39], s67 offen offset:1024 nt lds
    v_xor_b32 v3, 144, v2
    buffer_load_dwordx4 v3, s[36:39], s67 offen offset:2048 nt lds
    v_xor_b32 v3, 208, v2
    buffer_load_dwordx4 v3, s[36:39], s67 offen offset:3072 nt lds
    s_add_u32 m0, s68, 8192
    s_add_u32 s67, s67, 4096
    v_xor_b32 v3, 32, v2
    buffer_load_dwordx4 v3, s[36:39], s67 offen offset:0 nt lds
    v_xor_b32 v3, 96, v2
    buffer_load_dwordx4 v3, s[36:39], s67 offen offset:1024 nt lds
    v_xor_b32 v3, 160, v2
    buffer_load_dwordx4 v3, s[36:39], s67 offen offset:2048 nt lds
    v_xor_b32 v3, 224, v2
    buffer_load_dwordx4 v3, s[36:39], s67 offen offset:3072 nt lds
    s_waitcnt vmcnt(11)
    s_add_u32 m0, s68, 12288
    s_add_u32 s67, s67, 4096
    v_xor_b32 v3, 48, v2
    buffer_load_dwordx4 v3, s[36:39], s67 offen offset:0 nt lds
    v_and_b32 v10, 31, v1
    v_lshrrev_b32 v11, 5, v1
    v_and_b32 v12, 3, v1
    v_bfe_u32 v13, v1, 2, 2
    v_lshl_or_b32 v12, v12, 2, v13
    v_xor_b32 v12, v12, v11
    v_lshlrev_b32 v12, 4, v12
    v_lshl_add_u32 v16, v10, 10, v12
    v_add_u32 v16, s68, v16
    v_lshl_add_u32 v24, v10, 9, v12
    v_xor_b32 v17, 32, v16
    v_xor_b32 v25, 32, v24
    v_xor_b32 v18, 64, v16
    v_xor_b32 v26, 64, v24
    v_xor_b32 v19, 96, v16
    v_xor_b32 v27, 96, v24
    v_xor_b32 v20, 128, v16
    v_xor_b32 v28, 128, v24
    v_xor_b32 v21, 160, v16
    v_xor_b32 v29, 160, v24
    v_xor_b32 v22, 192, v16
    v_xor_b32 v30, 192, v24
    v_xor_b32 v23, 224, v16
    v_xor_b32 v31, 224, v24
    s_waitcnt vmcnt(11)
    v_xor_b32 v3, 112, v2
    buffer_load_dwordx4 v3, s[36:39], s67 offen offset:1024 nt lds
    s_waitcnt vmcnt(11)
    v_xor_b32 v3, 176, v2
    buffer_load_dwordx4 v3, s[36:39], s67 offen offset:2048 nt lds
    s_waitcnt vmcnt(11)
    v_xor_b32 v3, 240, v2
    buffer_load_dwordx4 v3, s[36:39], s67 offen offset:3072 nt lds
    s_waitcnt vmcnt(11)
    s_add_u32 m0, s68, 16384
    s_add_u32 s67, s67, 4096
    buffer_load_dwordx4 v2, s[36:39], s67 offen offset:0 nt lds
    s_waitcnt vmcnt(11)
    v_xor_b32 v3, 64, v2
    buffer_load_dwordx4 v3, s[36:39], s67 offen offset:1024 nt lds
    s_waitcnt vmcnt(11)
    v_xor_b32 v3, 128, v2
    buffer_load_dwordx4 v3, s[36:39], s67 offen offset:2048 nt lds
    s_waitcnt vmcnt(11)
    v_xor_b32 v3, 192, v2
    buffer_load_dwordx4 v3, s[36:39], s67 offen offset:3072 nt lds
    s_waitcnt vmcnt(11)
    s_add_u32 m0, s68, 20480
    s_add_u32 s67, s67, 4096
    v_xor_b32 v3, 16, v2
    buffer_load_dwordx4 v3, s[36:39], s67 offen offset:0 nt lds
    s_waitcnt vmcnt(11)
    v_xor_b32 v3, 80, v2
    buffer_load_dwordx4 v3, s[36:39], s67 offen offset:1024 nt lds
    s_waitcnt vmcnt(11)
    v_xor_b32 v3, 144, v2
    buffer_load_dwordx4 v3, s[36:39], s67 offen offset:2048 nt lds
    s_waitcnt vmcnt(11)
    v_xor_b32 v3, 208, v2
    buffer_load_dwordx4 v3, s[36:39], s67 offen offset:3072 nt lds
    s_waitcnt vmcnt(11)
    s_add_u32 m0, s68, 24576
    s_add_u32 s67, s67, 4096
    v_xor_b32 v3, 32, v2
    buffer_load_dwordx4 v3, s[36:39], s67 offen offset:0 nt lds
    v_and_b32 v4, 31, v1
    v_lshlrev_b32 v4, 7, v4
    s_lshl_b32 s57, s60, 12
    s_lshr_b32 s3, s66, 5
    s_lshl_b32 s3, s3, 3
    s_add_u32 s57, s57, s3
    s_add_u32 s57, s57, 0x14000
    buffer_load_dwordx2 v[6:7], v4, s[4:7], s57 offen sc1
    s_waitcnt vmcnt(11)
    v_xor_b32 v3, 96, v2
    buffer_load_dwordx4 v3, s[36:39], s67 offen offset:1024 nt lds
    s_waitcnt vmcnt(11)
    v_xor_b32 v3, 160, v2
    buffer_load_dwordx4 v3, s[36:39], s67 offen offset:2048 nt lds
    s_waitcnt vmcnt(11)
    v_xor_b32 v3, 224, v2
    buffer_load_dwordx4 v3, s[36:39], s67 offen offset:3072 nt lds
    s_waitcnt vmcnt(11)
    s_add_u32 m0, s68, 28672
    s_add_u32 s67, s67, 4096
    v_xor_b32 v3, 48, v2
    buffer_load_dwordx4 v3, s[36:39], s67 offen offset:0 nt lds
    s_waitcnt vmcnt(11)
    v_xor_b32 v3, 112, v2
    buffer_load_dwordx4 v3, s[36:39], s67 offen offset:1024 nt lds
    s_waitcnt vmcnt(11)
    v_xor_b32 v3, 176, v2
    buffer_load_dwordx4 v3, s[36:39], s67 offen offset:2048 nt lds
    s_waitcnt vmcnt(11)
    v_xor_b32 v3, 240, v2
    buffer_load_dwordx4 v3, s[36:39], s67 offen offset:3072 nt lds
    s_and_b32 s3, s60, 1
    s_lshl_b32 s3, s3, 1
    v_xor_b32 v12, s3, v10
    v_lshlrev_b32 v12, 4, v12
    v_lshl_add_u32 v12, v11, 14, v12
    s_lshl_b32 s3, s60, 12
    v_add_u32 v12, s3, v12
    s_lshr_b32 s3, s66, 5
    s_lshl_b32 s3, s3, 15
    s_lshl_b32 s69, s60, 13
    s_add_u32 s3, s3, s69
    s_add_u32 s3, s3, 0x100000
    s_add_u32 s69, s3, 4096
    s_mov_b32 s55, 0
    s_waitcnt vmcnt(7)
    v_cmp_ne_u32 vcc, s63, v6
    s_cbranch_vccnz K_6
    buffer_load_dwordx4 v[32:35], v2, s[4:7], s3 offen offset:0 sc1
    buffer_load_dwordx4 v[36:39], v2, s[4:7], s3 offen offset:1024 sc1
    buffer_load_dwordx4 v[40:43], v2, s[4:7], s3 offen offset:2048 sc1
    buffer_load_dwordx4 v[44:47], v2, s[4:7], s3 offen offset:3072 sc1
    buffer_load_dwordx4 v[48:51], v2, s[4:7], s69 offen offset:0 sc1
    buffer_load_dwordx4 v[52:55], v2, s[4:7], s69 offen offset:1024 sc1
    buffer_load_dwordx4 v[56:59], v2, s[4:7], s69 offen offset:2048 sc1
    buffer_load_dwordx4 v[60:63], v2, s[4:7], s69 offen offset:3072 sc1
    s_waitcnt vmcnt(8)
    s_mov_b32 s55, 1
    ds_read_b128 v[208:211], v16 offset:0
    ds_read_b128 v[212:215], v17 offset:0
    ds_read_b128 v[216:219], v18 offset:0
    ds_read_b128 v[220:223], v19 offset:0
    ds_read_b128 v[224:227], v20 offset:0
    ds_read_b128 v[228:231], v21 offset:0
    ds_read_b128 v[232:235], v22 offset:0
    ds_read_b128 v[236:239], v23 offset:0
    ds_read_b128 v[240:243], v16 offset:256
    ds_read_b128 v[244:247], v17 offset:256
    ds_read_b128 v[248:251], v18 offset:256
    ds_read_b128 v[252:255], v19 offset:256
    ds_read_b128 v[128:131], v20 offset:256
    ds_read_b128 v[132:135], v21 offset:256
    ds_read_b128 v[136:139], v22 offset:256
    ds_read_b128 v[140:143], v23 offset:256
    ds_read_b128 v[144:147], v16 offset:512
    ds_read_b128 v[148:151], v17 offset:512
    ds_read_b128 v[152:155], v18 offset:512
    ds_read_b128 v[156:159], v19 offset:512
    ds_read_b128 v[160:163], v20 offset:512
    ds_read_b128 v[164:167], v21 offset:512
    ds_read_b128 v[168:171], v22 offset:512
    ds_read_b128 v[172:175], v23 offset:512
    ds_read_b128 v[176:179], v16 offset:768
    ds_read_b128 v[180:183], v17 offset:768
    ds_read_b128 v[184:187], v18 offset:768
    ds_read_b128 v[188:191], v19 offset:768
    ds_read_b128 v[192:195], v20 offset:768
    ds_read_b128 v[196:199], v21 offset:768
    ds_read_b128 v[200:203], v22 offset:768
    ds_read_b128 v[204:207], v23 offset:768
    v_cmp_gt_u32 vcc, 32, v1
    s_nop 1
    v_cndmask_b32 v5, 0, v7, vcc
    v_sub_u32 v5, 0, v5
    s_waitcnt vmcnt(7)
    ds_write_b128 v12, v[32:35] offset:0
    v_add3_u32 v5, v5, v32, v33
    v_add3_u32 v5, v5, v34, v35
    s_waitcnt vmcnt(6)
    v_xor_b32 v14, 64, v12
    ds_write_b128 v14, v[36:39] offset:512
    v_add3_u32 v5, v5, v36, v37
    v_add3_u32 v5, v5, v38, v39
    s_waitcnt vmcnt(5)
    v_xor_b32 v13, 128, v12
    ds_write_b128 v13, v[40:43] offset:1024
    v_add3_u32 v5, v5, v40, v41
    v_add3_u32 v5, v5, v42, v43
    s_waitcnt vmcnt(4)
    v_xor_b32 v14, 192, v12
    ds_write_b128 v14, v[44:47] offset:1536
    v_add3_u32 v5, v5, v44, v45
    v_add3_u32 v5, v5, v46, v47
    s_waitcnt vmcnt(3)
    v_xor_b32 v13, 16, v12
    ds_write_b128 v13, v[48:51] offset:2048
    v_add3_u32 v5, v5, v48, v49
    v_add3_u32 v5, v5, v50, v51
    s_waitcnt vmcnt(2)
    v_xor_b32 v14, 80, v12
    ds_write_b128 v14, v[52:55] offset:2560
    v_add3_u32 v5, v5, v52, v53
    v_add3_u32 v5, v5, v54, v55
    s_waitcnt vmcnt(1)
    v_xor_b32 v13, 144, v12
    ds_write_b128 v13, v[56:59] offset:3072
    v_add3_u32 v5, v5, v56, v57
    v_add3_u32 v5, v5, v58, v59
    s_waitcnt vmcnt(0)
    v_xor_b32 v14, 208, v12
    ds_write_b128 v14, v[60:63] offset:3584
    v_add3_u32 v5, v5, v60, v61
    v_add3_u32 v5, v5, v62, v63
    s_nop 1
    v_add_u32_dpp v5, v5, v5 row_ror:1 row_mask:0xf bank_mask:0xf
    s_nop 1
    v_add_u32_dpp v5, v5, v5 row_ror:2 row_mask:0xf bank_mask:0xf
    s_nop 1
    v_add_u32_dpp v5, v5, v5 row_ror:4 row_mask:0xf bank_mask:0xf
    s_nop 1
    v_add_u32_dpp v5, v5, v5 row_ror:8 row_mask:0xf bank_mask:0xf
    v_mov_b32 v8, v5
    s_nop 1
    v_permlane16_swap_b32 v5, v8
    v_add_u32 v5, v5, v8
    v_mov_b32 v8, v5
    s_nop 1
    v_permlane32_swap_b32 v5, v8
    v_add_u32 v5, v5, v8
    v_cmp_ne_u32 vcc, 0, v5
    s_cbranch_vccz K_7
K_6:
    s_waitcnt vmcnt(0)
    s_mov_b32 s58, -1
K_8:
    buffer_load_dwordx2 v[6:7], v4, s[4:7], s57 offen sc1
    s_and_b32 s56, s58, 0xf
    s_cbranch_scc0 S_11
    buffer_load_dwordx4 v[32:35], v2, s[4:7], s3 offen offset:0 sc1
S_11:
    s_and_b32 s56, s58, 0xf0
    s_cbranch_scc0 S_12
    buffer_load_dwordx4 v[36:39], v2, s[4:7], s3 offen offset:1024 sc1
S_12:
    s_and_b32 s56, s58, 0xf00
    s_cbranch_scc0 S_13
    buffer_load_dwordx4 v[40:43], v2, s[4:7], s3 offen offset:2048 sc1
S_13:
    s_and_b32 s56, s58, 0xf000
    s_cbranch_scc0 S_14
    buffer_load_dwordx4 v[44:47], v2, s[4:7], s3 offen offset:3072 sc1
S_14:
    s_and_b32 s56, s58, 0xf0000
    s_cbranch_scc0 S_15
    buffer_load_dwordx4 v[48:51], v2, s[4:7], s69 offen offset:0 sc1
S_15:
    s_and_b32 s56, s58, 0xf00000
    s_cbranch_scc0 S_16
    buffer_load_dwordx4 v[52:55], v2, s[4:7], s69 offen offset:1024 sc1
S_16:
    s_and_b32 s56, s58, 0xf000000
    s_cbranch_scc0 S_17
    buffer_load_dwordx4 v[56:59], v2, s[4:7], s69 offen offset:2048 sc1
S_17:
    s_and_b32 s56, s58, 0xf0000000
    s_cbranch_scc0 S_18
    buffer_load_dwordx4 v[60:63], v2, s[4:7], s69 offen offset:3072 sc1
S_18:
    s_cmp_lg_u32 s55, 0
    s_cbranch_scc1 S_19
    s_mov_b32 s55, 1
    ds_read_b128 v[208:211], v16 offset:0
    ds_read_b128 v[212:215], v17 offset:0
    ds_read_b128 v[216:219], v18 offset:0
    ds_read_b128 v[220:223], v19 offset:0
    ds_read_b128 v[224:227], v20 offset:0
    ds_read_b128 v[228:231], v21 offset:0
    ds_read_b128 v[232:235], v22 offset:0
    ds_read_b128 v[236:239], v23 offset:0
    ds_read_b128 v[240:243], v16 offset:256
    ds_read_b128 v[244:247], v17 offset:256
    ds_read_b128 v[248:251], v18 offset:256
    ds_read_b128 v[252:255], v19 offset:256
    ds_read_b128 v[128:131], v20 offset:256
    ds_read_b128 v[132:135], v21 offset:256
    ds_read_b128 v[136:139], v22 offset:256
    ds_read_b128 v[140:143], v23 offset:256
    ds_read_b128 v[144:147], v16 offset:512
    ds_read_b128 v[148:151], v17 offset:512
    ds_read_b128 v[152:155], v18 offset:512
    ds_read_b128 v[156:159], v19 offset:512
    ds_read_b128 v[160:163], v20 offset:512
    ds_read_b128 v[164:167], v21 offset:512
    ds_read_b128 v[168:171], v22 offset:512
    ds_read_b128 v[172:175], v23 offset:512
    ds_read_b128 v[176:179], v16 offset:768
    ds_read_b128 v[180:183], v17 offset:768
    ds_read_b128 v[184:187], v18 offset:768
    ds_read_b128 v[188:191], v19 offset:768
    ds_read_b128 v[192:195], v20 offset:768
    ds_read_b128 v[196:199], v21 offset:768
    ds_read_b128 v[200:203], v22 offset:768
    ds_read_b128 v[204:207], v23 offset:768
S_19:
K_8_w:
    s_waitcnt vmcnt(0)
    v_cmp_ne_u32 vcc, s63, v6
    s_add_u32 s64, s64, 1
    s_cmp_gt_u32 s64, 200000
    s_cbranch_scc1 K_7
    s_mov_b32 s58, vcc_lo
    s_cbranch_vccz K_9
    s_sleep 1
    s_branch K_8
K_9:
    v_cmp_gt_u32 vcc, 32, v1
    s_nop 1
    v_cndmask_b32 v5, 0, v7, vcc
    v_sub_u32 v5, 0, v5
    ds_write_b128 v12, v[32:35] offset:0
    v_add3_u32 v5, v5, v32, v33
    v_add3_u32 v5, v5, v34, v35
    v_xor_b32 v14, 64, v12
    ds_write_b128 v14, v[36:39] offset:512
    v_add3_u32 v5, v5, v36, v37
    v_add3_u32 v5, v5, v38, v39
    v_xor_b32 v13, 128, v12
    ds_write_b128 v13, v[40:43] offset:1024
    v_add3_u32 v5, v5, v40, v41
    v_add3_u32 v5, v5, v42, v43
    v_xor_b32 v14, 192, v12
    ds_write_b128 v14, v[44:47] offset:1536
    v_add3_u32 v5, v5, v44, v45
    v_add3_u32 v5, v5, v46, v47
    v_xor_b32 v13, 16, v12
    ds_write_b128 v13, v[48:51] offset:2048
    v_add3_u32 v5, v5, v48, v49
    v_add3_u32 v5, v5, v50, v51
    v_xor_b32 v14, 80, v12
    ds_write_b128 v14, v[52:55] offset:2560
    v_add3_u32 v5, v5, v52, v53
    v_add3_u32 v5, v5, v54, v55
    v_xor_b32 v13, 144, v12
    ds_write_b128 v13, v[56:59] offset:3072
    v_add3_u32 v5, v5, v56, v57
    v_add3_u32 v5, v5, v58, v59
    v_xor_b32 v14, 208, v12
    ds_write_b128 v14, v[60:63] offset:3584
    v_add3_u32 v5, v5, v60, v61
    v_add3_u32 v5, v5, v62, v63
    s_nop 1
    v_add_u32_dpp v5, v5, v5 row_ror:1 row_mask:0xf bank_mask:0xf
    s_nop 1
    v_add_u32_dpp v5, v5, v5 row_ror:2 row_mask:0xf bank_mask:0xf
    s_nop 1
    v_add_u32_dpp v5, v5, v5 row_ror:4 row_mask:0xf bank_mask:0xf
    s_nop 1
    v_add_u32_dpp v5, v5, v5 row_ror:8 row_mask:0xf bank_mask:0xf
    v_mov_b32 v8, v5
    s_nop 1
    v_permlane16_swap_b32 v5, v8
    v_add_u32 v5, v5, v8
    v_mov_b32 v8, v5
    s_nop 1
    v_permlane32_swap_b32 v5, v8
    v_add_u32 v5, v5, v8
    v_cmp_ne_u32 vcc, 0, v5
    s_mov_b32 s58, -1
    s_cbranch_vccnz K_8
K_7:
    s_waitcnt lgkmcnt(0)
    s_barrier
    ds_read_b128 v[64:67], v24 offset:0
    ds_read_b128 v[68:71], v25 offset:0
    ds_read_b128 v[72:75], v26 offset:0
    ds_read_b128 v[76:79], v27 offset:0
    ds_read_b128 v[80:83], v28 offset:0
    ds_read_b128 v[84:87], v29 offset:0
    ds_read_b128 v[88:91], v30 offset:0
    s_waitcnt lgkmcnt(6)
    v_mfma_f32_32x32x16_bf16 v[96:111], v[208:211], v[64:67], 0
    ds_read_b128 v[92:95], v31 offset:0
    v_bfe_u32 v13, v1, 2, 2
    v_and_b32 v14, 1, v1
    v_bfe_u32 v15, v1, 4, 1
    s_waitcnt lgkmcnt(4)
    v_mfma_f32_32x32x16_bf16 v[96:111], v[212:215], v[68:71], v[96:111]
    ds_read_b128 v[64:67], v24 offset:256
    v_lshl_or_b32 v14, v14, 1, v15
    v_xor_b32 v14, v14, v11
    v_lshl_or_b32 v14, v13, 2, v14
    v_mfma_f32_32x32x16_bf16 v[96:111], v[216:219], v[72:75], v[96:111]
    ds_read_b128 v[68:71], v25 offset:256
    v_lshlrev_b32 v14, 4, v14
    v_lshl_add_u32 v13, v11, 2, v13
    v_lshl_add_u32 v14, v13, 10, v14
    v_mfma_f32_32x32x16_bf16 v[96:111], v[220:223], v[76:79], v[96:111]
    ds_read_b128 v[72:75], v26 offset:256
    v_bfe_u32 v15, v1, 1, 1
    v_lshl_add_u32 v14, v15, 3, v14
    s_lshl_b32 s3, s60, 8
    s_waitcnt lgkmcnt(3)
    v_mfma_f32_32x32x16_bf16 v[96:111], v[224:227], v[80:83], v[96:111]
    ds_read_b128 v[76:79], v27 offset:256
    s_add_u32 s3, s3, 32768
    v_add_u32 v120, s3, v14
    v_mov_b32 v4, v120
    v_mfma_f32_32x32x16_bf16 v[96:111], v[228:231], v[84:87], v[96:111]
    ds_read_b128 v[80:83], v28 offset:256
    v_xor_b32 v5, 32, v120
    v_add_u32 v5, 8192, v5
    v_add_u32 v6, 0x10000, v4
    v_mfma_f32_32x32x16_bf16 v[96:111], v[232:235], v[88:91], v[96:111]
    ds_read_b128 v[84:87], v29 offset:256
    v_add_u32 v7, 0x10000, v5
    v_lshlrev_b32 v13, 5, v10
    s_lshl_b32 s3, s60, 3
    v_mfma_f32_32x32x16_bf16 v[96:111], v[236:239], v[92:95], v[96:111]
    ds_read_b128 v[88:91], v30 offset:256
    v_add_u32 v14, s3, v13
    v_and_b32 v15, 7, v10
    v_lshlrev_b32 v8, 1, v11
    s_waitcnt lgkmcnt(3)
    v_mfma_f32_32x32x16_bf16 v[96:111], v[240:243], v[64:67], v[96:111]
    ds_read_b128 v[92:95], v31 offset:256
    v_xor_b32 v8, v8, v15
    v_lshlrev_b32 v8, 4, v8
    v_lshl_add_u32 v8, v10, 7, v8
    v_mfma_f32_32x32x16_bf16 v[96:111], v[244:247], v[68:71], v[96:111]
    ds_read_b128 v[64:67], v24 offset:16384
    s_lshl_b32 s3, s60, 12
    s_add_u32 s3, s3, 16384
    v_add_u32 v8, s3, v8
    v_mfma_f32_32x32x16_bf16 v[96:111], v[248:251], v[72:75], v[96:111]
    ds_read_b128 v[68:71], v25 offset:16384
    v_lshrrev_b32 v15, 3, v1
    v_and_b32 v3, 7, v1
    v_xor_b32 v9, v3, v15
    v_mfma_f32_32x32x16_bf16 v[96:111], v[252:255], v[76:79], v[96:111]
    ds_read_b128 v[72:75], v26 offset:16384
    v_lshlrev_b32 v9, 4, v9
    v_lshl_add_u32 v9, v15, 7, v9
    v_add_u32 v9, s3, v9
    s_waitcnt lgkmcnt(3)
    v_mfma_f32_32x32x16_bf16 v[96:111], v[128:131], v[80:83], v[96:111]
    ds_read_b128 v[76:79], v27 offset:16384
    v_lshlrev_b32 v3, 4, v3
    v_lshl_add_u32 v3, v15, 17, v3
    s_lshl_b32 s3, s60, 11
    v_mfma_f32_32x32x16_bf16 v[96:111], v[132:135], v[84:87], v[96:111]
    ds_read_b128 v[80:83], v28 offset:16384
    v_add_u32 v15, s3, v2
    s_and_b32 s67, s66, 31
    s_lshl_b32 s67, s67, 10
    v_mfma_f32_32x32x16_bf16 v[96:111], v[136:139], v[88:91], v[96:111]
    ds_read_b128 v[84:87], v29 offset:16384
    s_lshr_b32 s3, s66, 5
    s_lshl_b32 s3, s3, 8
    s_add_u32 s67, s67, s3
    v_mfma_f32_32x32x16_bf16 v[96:111], v[140:143], v[92:95], v[96:111]
    ds_read_b128 v[88:91], v30 offset:16384
    s_lshl_b32 s3, s60, 15
    s_add_u32 s67, s67, s3
    s_add_u32 s67, s67, 0x400000
    s_waitcnt lgkmcnt(3)
    s_barrier
    v_mfma_f32_32x32x16_bf16 v[96:111], v[144:147], v[64:67], v[96:111]
    ds_read_b128 v[92:95], v31 offset:16384
    s_mov_b32 s69, 0x3f803f80
    v_xor_b32 v240, 64, v4
    v_xor_b32 v241, 64, v5
    v_mfma_f32_32x32x16_bf16 v[96:111], v[148:151], v[68:71], v[96:111]
    ds_read_b128 v[64:67], v24 offset:16640
    v_xor_b32 v242, 64, v6
    v_xor_b32 v243, 64, v7
    v_mfma_f32_32x32x16_bf16 v[96:111], v[152:155], v[72:75], v[96:111]
    ds_read_b128 v[68:71], v25 offset:16640
    v_mfma_f32_32x32x16_bf16 v[96:111], v[156:159], v[76:79], v[96:111]
    ds_read_b128 v[72:75], v26 offset:16640
    s_waitcnt lgkmcnt(3)
    v_mfma_f32_32x32x16_bf16 v[96:111], v[160:163], v[80:83], v[96:111]
    ds_read_b128 v[76:79], v27 offset:16640
    v_mfma_f32_32x32x16_bf16 v[96:111], v[164:167], v[84:87], v[96:111]
    ds_read_b128 v[80:83], v28 offset:16640
    v_mfma_f32_32x32x16_bf16 v[96:111], v[168:171], v[88:91], v[96:111]
    ds_read_b128 v[84:87], v29 offset:16640
    v_mfma_f32_32x32x16_bf16 v[96:111], v[172:175], v[92:95], v[96:111]
    ds_read_b128 v[88:91], v30 offset:16640
    s_waitcnt lgkmcnt(3)
    v_mfma_f32_32x32x16_bf16 v[96:111], v[176:179], v[64:67], v[96:111]
    ds_read_b128 v[92:95], v31 offset:16640
    v_mfma_f32_32x32x16_bf16 v[96:111], v[180:183], v[68:71], v[96:111]
    ds_read_b64_tr_b16 v[208:209], v4 offset:0
    ds_read_b64_tr_b16 v[210:211], v5 offset:0
    v_mfma_f32_32x32x16_bf16 v[96:111], v[184:187], v[72:75], v[96:111]
    ds_read_b64_tr_b16 v[212:213], v240 offset:0
    ds_read_b64_tr_b16 v[214:215], v241 offset:0
    v_mfma_f32_32x32x16_bf16 v[96:111], v[188:191], v[76:79], v[96:111]
    ds_read_b64_tr_b16 v[216:217], v4 offset:16384
    ds_read_b64_tr_b16 v[218:219], v5 offset:16384
    s_waitcnt lgkmcnt(6)
    v_mfma_f32_32x32x16_bf16 v[96:111], v[192:195], v[80:83], v[96:111]
    ds_read_b64_tr_b16 v[220:221], v240 offset:16384
    ds_read_b64_tr_b16 v[222:223], v241 offset:16384
    v_mfma_f32_32x32x16_bf16 v[96:111], v[196:199], v[84:87], v[96:111]
    ds_read_b64_tr_b16 v[224:225], v4 offset:32768
    ds_read_b64_tr_b16 v[226:227], v5 offset:32768
    v_mfma_f32_32x32x16_bf16 v[96:111], v[200:203], v[88:91], v[96:111]
    ds_read_b64_tr_b16 v[228:229], v240 offset:32768
    ds_read_b64_tr_b16 v[230:231], v241 offset:32768
    v_mfma_f32_32x32x16_bf16 v[96:111], v[204:207], v[92:95], v[96:111]
    ds_read_b64_tr_b16 v[232:233], v4 offset:49152
    ds_read_b64_tr_b16 v[234:235], v5 offset:49152
    s_nop 9
    v_max3_f32 v122, v96, v97, v98
    v_max3_f32 v121, v99, v100, v101
    v_max3_f32 v122, v122, v102, v103
    v_max3_f32 v121, v121, v104, v105
    v_max3_f32 v122, v122, v106, v107
    v_max3_f32 v121, v121, v108, v109
    v_max3_f32 v122, v122, v110, v111
    v_max_f32 v122, v122, v121
    v_mov_b32 v121, v122
    s_nop 1
    v_permlane32_swap_b32 v122, v121
    v_max_f32 v122, v122, v121
    v_ceil_f32 v122, v122
    v_pk_add_f32 v[96:97], v[96:97], v[122:123] op_sel_hi:[1,0] neg_lo:[0,1] neg_hi:[0,1]
    v_pk_add_f32 v[98:99], v[98:99], v[122:123] op_sel_hi:[1,0] neg_lo:[0,1] neg_hi:[0,1]
    v_pk_add_f32 v[100:101], v[100:101], v[122:123] op_sel_hi:[1,0] neg_lo:[0,1] neg_hi:[0,1]
    v_pk_add_f32 v[102:103], v[102:103], v[122:123] op_sel_hi:[1,0] neg_lo:[0,1] neg_hi:[0,1]
    v_pk_add_f32 v[104:105], v[104:105], v[122:123] op_sel_hi:[1,0] neg_lo:[0,1] neg_hi:[0,1]
    v_pk_add_f32 v[106:107], v[106:107], v[122:123] op_sel_hi:[1,0] neg_lo:[0,1] neg_hi:[0,1]
    v_pk_add_f32 v[108:109], v[108:109], v[122:123] op_sel_hi:[1,0] neg_lo:[0,1] neg_hi:[0,1]
    v_pk_add_f32 v[110:111], v[110:111], v[122:123] op_sel_hi:[1,0] neg_lo:[0,1] neg_hi:[0,1]
    v_exp_f32 v96, v96
    v_exp_f32 v97, v97
    v_exp_f32 v98, v98
    v_exp_f32 v99, v99
    v_exp_f32 v100, v100
    v_exp_f32 v101, v101
    v_exp_f32 v102, v102
    v_exp_f32 v103, v103
    v_cvt_pk_bf16_f32 v112, v96, v97
    v_cvt_pk_bf16_f32 v113, v98, v99
    v_cvt_pk_bf16_f32 v114, v100, v101
    v_cvt_pk_bf16_f32 v115, v102, v103
    ds_write_b128 v15, v[112:115] offset:0
    v_exp_f32 v104, v104
    v_exp_f32 v105, v105
    v_exp_f32 v106, v106
    v_exp_f32 v107, v107
    v_exp_f32 v108, v108
    v_exp_f32 v109, v109
    v_exp_f32 v110, v110
    v_exp_f32 v111, v111
    v_cvt_pk_bf16_f32 v116, v104, v105
    v_cvt_pk_bf16_f32 v117, v106, v107
    v_cvt_pk_bf16_f32 v118, v108, v109
    v_cvt_pk_bf16_f32 v119, v110, v111
    ds_write_b128 v15, v[116:119] offset:1024
    v_dot2_f32_bf16 v123, v112, s69, 0
    v_dot2_f32_bf16 v121, v116, s69, 0
    v_dot2_f32_bf16 v123, v113, s69, v123
    v_dot2_f32_bf16 v121, v117, s69, v121
    v_dot2_f32_bf16 v123, v114, s69, v123
    v_dot2_f32_bf16 v121, v118, s69, v121
    v_dot2_f32_bf16 v123, v115, s69, v123
    v_dot2_f32_bf16 v121, v119, s69, v121
    s_nop 2
    v_add_f32 v123, v123, v121
    v_mov_b32 v121, v123
    s_nop 1
    v_permlane32_swap_b32 v123, v121
    v_add_f32 v123, v123, v121
    ds_write_b64 v14, v[122:123] offset:8192
    s_cmp_ge_u32 s66, 112
    s_cbranch_scc1 A_20
    v_mov_b32 v124, -1
    v_mov_b32 v125, -1
    v_mov_b32 v126, -1
    v_mov_b32 v127, -1
    s_lshl_b32 s3, s66, 2
    s_add_u32 s3, s3, s60
    s_lshl_b32 s3, s3, 10
    s_add_u32 s3, s3, 0x180000
    buffer_store_dwordx4 v[124:127], v2, s[4:7], s3 offen sc1
A_20:
    s_waitcnt lgkmcnt(0)
    s_barrier
    ds_read_b128 v[104:107], v13 offset:8192
    ds_read_b128 v[108:111], v13 offset:8208
    ds_read_b128 v[32:35], v2 offset:0
    ds_read_b128 v[36:39], v2 offset:1024
    ds_read_b128 v[40:43], v2 offset:2048
    ds_read_b128 v[44:47], v2 offset:3072
    ds_read_b128 v[48:51], v2 offset:4096
    ds_read_b128 v[52:55], v2 offset:5120
    ds_read_b128 v[56:59], v2 offset:6144
    ds_read_b128 v[60:63], v2 offset:7168
    s_mov_b32 s58, 0x800080
    s_waitcnt lgkmcnt(8)
    v_max3_f32 v122, v104, v106, v108
    v_max_f32 v122, v122, v110
    v_sub_f32 v96, v122, v104
    v_cvt_u32_f32 v96, v96
    v_min_u32 v96, 0xff, v96
    v_mul_u32_u24 v100, s58, v96
    s_waitcnt lgkmcnt(7)
    v_pk_sub_u16 v32, v32, v100 clamp
    v_pk_sub_u16 v33, v33, v100 clamp
    v_pk_sub_u16 v34, v34, v100 clamp
    v_pk_sub_u16 v35, v35, v100 clamp
    s_nop 1
    v_mfma_f32_32x32x16_bf16 v[128:143], v[208:211], v[32:35], 0
    ds_read_b64_tr_b16 v[236:237], v240 offset:49152
    ds_read_b64_tr_b16 v[238:239], v241 offset:49152
    s_waitcnt lgkmcnt(8)
    v_pk_sub_u16 v36, v36, v100 clamp
    v_pk_sub_u16 v37, v37, v100 clamp
    v_sub_f32 v97, v122, v106
    v_cvt_u32_f32 v97, v97
    v_mfma_f32_32x32x16_bf16 v[144:159], v[212:215], v[32:35], 0
    ds_read_b64_tr_b16 v[208:209], v6 offset:0
    ds_read_b64_tr_b16 v[210:211], v7 offset:0
    v_pk_sub_u16 v38, v38, v100 clamp
    v_pk_sub_u16 v39, v39, v100 clamp
    v_min_u32 v97, 0xff, v97
    v_mul_u32_u24 v101, s58, v97
    v_mfma_f32_32x32x16_bf16 v[128:143], v[216:219], v[36:39], v[128:143]
    ds_read_b64_tr_b16 v[212:213], v242 offset:0
    ds_read_b64_tr_b16 v[214:215], v243 offset:0
    s_waitcnt lgkmcnt(11)
    v_pk_sub_u16 v40, v40, v101 clamp
    v_pk_sub_u16 v41, v41, v101 clamp
    v_sub_f32 v98, v122, v108
    v_cvt_u32_f32 v98, v98
    v_mfma_f32_32x32x16_bf16 v[144:159], v[220:223], v[36:39], v[144:159]
    ds_read_b64_tr_b16 v[216:217], v6 offset:16384
    ds_read_b64_tr_b16 v[218:219], v7 offset:16384
    v_pk_sub_u16 v42, v42, v101 clamp
    v_pk_sub_u16 v43, v43, v101 clamp
    v_min_u32 v98, 0xff, v98
    v_mul_u32_u24 v102, s58, v98
    s_waitcnt lgkmcnt(6)
    v_mfma_f32_32x32x16_bf16 v[128:143], v[224:227], v[40:43], v[128:143]
    ds_read_b64_tr_b16 v[220:221], v242 offset:16384
    ds_read_b64_tr_b16 v[222:223], v243 offset:16384
    s_waitcnt lgkmcnt(14)
    v_pk_sub_u16 v44, v44, v101 clamp
    v_pk_sub_u16 v45, v45, v101 clamp
    v_sub_f32 v99, v122, v110
    v_cvt_u32_f32 v99, v99
    v_mfma_f32_32x32x16_bf16 v[144:159], v[228:231], v[40:43], v[144:159]
    ds_read_b64_tr_b16 v[224:225], v6 offset:32768
    ds_read_b64_tr_b16 v[226:227], v7 offset:32768
    v_pk_sub_u16 v46, v46, v101 clamp
    v_pk_sub_u16 v47, v47, v101 clamp
    v_min_u32 v99, 0xff, v99
    v_mul_u32_u24 v103, s58, v99
    v_mfma_f32_32x32x16_bf16 v[128:143], v[232:235], v[44:47], v[128:143]
    ds_read_b64_tr_b16 v[228:229], v242 offset:32768
    ds_read_b64_tr_b16 v[230:231], v243 offset:32768
    s_waitcnt lgkmcnt(15)
    v_pk_sub_u16 v48, v48, v102 clamp
    v_pk_sub_u16 v49, v49, v102 clamp
    v_pk_sub_u16 v50, v50, v102 clamp
    s_cmp_lg_u32 s60, 0
    s_cbranch_scc1 A_21
    v_sub_u32 v96, 0, v96
    v_sub_u32 v97, 0, v97
    v_sub_u32 v98, 0, v98
    v_sub_u32 v99, 0, v99
    v_ldexp_f32 v96, v105, v96
    v_ldexp_f32 v97, v107, v97
    v_ldexp_f32 v98, v109, v98
    v_ldexp_f32 v99, v111, v99
    v_add_f32 v96, v96, v97
    v_add_f32 v98, v98, v99
    v_add_f32 v123, v96, v98
    v_mov_b32 v124, s63
    s_lshl_b32 s3, s66, 9
    s_add_u32 s3, s3, 0x120000
    s_mov_b32 exec_hi, 0
    buffer_store_dwordx4 v[122:125], v2, s[4:7], s3 offen sc1
    s_mov_b64 exec, -1
A_21:
    v_mfma_f32_32x32x16_bf16 v[144:159], v[236:239], v[44:47], v[144:159]
    ds_read_b64_tr_b16 v[232:233], v6 offset:49152
    ds_read_b64_tr_b16 v[234:235], v7 offset:49152
    v_pk_sub_u16 v51, v51, v102 clamp
    s_nop 0
    s_waitcnt lgkmcnt(6)
    v_mfma_f32_32x32x16_bf16 v[128:143], v[208:211], v[48:51], v[128:143]
    ds_read_b64_tr_b16 v[236:237], v242 offset:49152
    ds_read_b64_tr_b16 v[238:239], v243 offset:49152
    s_waitcnt lgkmcnt(15)
    v_pk_sub_u16 v52, v52, v102 clamp
    v_pk_sub_u16 v53, v53, v102 clamp
    v_pk_sub_u16 v54, v54, v102 clamp
    v_mfma_f32_32x32x16_bf16 v[144:159], v[212:215], v[48:51], v[144:159]
    v_xor_b32 v4, 128, v120
    v_xor_b32 v5, 160, v120
    v_add_u32 v5, 8192, v5
    ds_read_b64_tr_b16 v[208:209], v4 offset:0
    ds_read_b64_tr_b16 v[210:211], v5 offset:0
    v_pk_sub_u16 v55, v55, v102 clamp
    s_nop 0
    s_nop 0
    v_mfma_f32_32x32x16_bf16 v[128:143], v[216:219], v[52:55], v[128:143]
    ds_read_b64_tr_b16 v[212:213], v4 offset:16384
    ds_read_b64_tr_b16 v[214:215], v5 offset:16384
    s_waitcnt lgkmcnt(15)
    v_pk_sub_u16 v56, v56, v103 clamp
    v_pk_sub_u16 v57, v57, v103 clamp
    v_pk_sub_u16 v58, v58, v103 clamp
    v_mfma_f32_32x32x16_bf16 v[144:159], v[220:223], v[52:55], v[144:159]
    ds_read_b64_tr_b16 v[216:217], v4 offset:32768
    ds_read_b64_tr_b16 v[218:219], v5 offset:32768
    v_pk_sub_u16 v59, v59, v103 clamp
    s_nop 0
    s_waitcnt lgkmcnt(6)
    v_mfma_f32_32x32x16_bf16 v[128:143], v[224:227], v[56:59], v[128:143]
    ds_read_b64_tr_b16 v[220:221], v4 offset:49152
    ds_read_b64_tr_b16 v[222:223], v5 offset:49152
    s_waitcnt lgkmcnt(15)
    v_pk_sub_u16 v60, v60, v103 clamp
    v_pk_sub_u16 v61, v61, v103 clamp
    v_pk_sub_u16 v62, v62, v103 clamp
    v_mfma_f32_32x32x16_bf16 v[144:159], v[228:231], v[56:59], v[144:159]
    v_add_u32 v6, 0x10000, v4
    v_add_u32 v7, 0x10000, v5
    ds_read_b64_tr_b16 v[224:225], v6 offset:0
    ds_read_b64_tr_b16 v[226:227], v7 offset:0
    v_pk_sub_u16 v63, v63, v103 clamp
    s_nop 0
    s_nop 0
    v_mfma_f32_32x32x16_bf16 v[128:143], v[232:235], v[60:63], v[128:143]
    ds_read_b64_tr_b16 v[228:229], v6 offset:16384
    ds_read_b64_tr_b16 v[230:231], v7 offset:16384
    v_mfma_f32_32x32x16_bf16 v[144:159], v[236:239], v[60:63], v[144:159]
    ds_read_b64_tr_b16 v[232:233], v6 offset:32768
    ds_read_b64_tr_b16 v[234:235], v7 offset:32768
    s_waitcnt lgkmcnt(6)
    v_mfma_f32_32x32x16_bf16 v[160:175], v[208:211], v[32:35], 0
    ds_read_b64_tr_b16 v[236:237], v6 offset:49152
    ds_read_b64_tr_b16 v[238:239], v7 offset:49152
    v_mfma_f32_32x32x16_bf16 v[160:175], v[212:215], v[36:39], v[160:175]
    v_xor_b32 v4, 192, v120
    v_xor_b32 v5, 224, v120
    v_add_u32 v5, 8192, v5
    ds_read_b64_tr_b16 v[208:209], v4 offset:0
    ds_read_b64_tr_b16 v[210:211], v5 offset:0
    v_cvt_pk_bf16_f32 v192, v128, v129
    v_cvt_pk_bf16_f32 v193, v130, v131
    v_cvt_pk_bf16_f32 v194, v132, v133
    v_cvt_pk_bf16_f32 v195, v134, v135
    v_cvt_pk_bf16_f32 v196, v136, v137
    v_mfma_f32_32x32x16_bf16 v[160:175], v[216:219], v[40:43], v[160:175]
    ds_read_b64_tr_b16 v[212:213], v4 offset:16384
    ds_read_b64_tr_b16 v[214:215], v5 offset:16384
    v_cvt_pk_bf16_f32 v197, v138, v139
    v_cvt_pk_bf16_f32 v198, v140, v141
    v_cvt_pk_bf16_f32 v199, v142, v143
    v_add3_u32 v121, v192, v193, v194
    v_add_u32 v121, v121, v195
    v_mfma_f32_32x32x16_bf16 v[160:175], v[220:223], v[44:47], v[160:175]
    ds_read_b64_tr_b16 v[216:217], v4 offset:32768
    ds_read_b64_tr_b16 v[218:219], v5 offset:32768
    v_add3_u32 v121, v121, v196, v197
    v_add3_u32 v121, v121, v198, v199
    ds_write_b128 v8, v[192:195]
    v_xor_b32 v14, 16, v8
    ds_write_b128 v14, v[196:199]
    s_waitcnt lgkmcnt(8)
    v_mfma_f32_32x32x16_bf16 v[160:175], v[224:227], v[48:51], v[160:175]
    ds_read_b64_tr_b16 v[220:221], v4 offset:49152
    ds_read_b64_tr_b16 v[222:223], v5 offset:49152
    v_cvt_pk_bf16_f32 v200, v144, v145
    v_cvt_pk_bf16_f32 v201, v146, v147
    v_cvt_pk_bf16_f32 v202, v148, v149
    v_cvt_pk_bf16_f32 v203, v150, v151
    v_cvt_pk_bf16_f32 v204, v152, v153
    v_mfma_f32_32x32x16_bf16 v[160:175], v[228:231], v[52:55], v[160:175]
    v_add_u32 v6, 0x10000, v4
    v_add_u32 v7, 0x10000, v5
    ds_read_b64_tr_b16 v[224:225], v6 offset:0
    ds_read_b64_tr_b16 v[226:227], v7 offset:0
    v_cvt_pk_bf16_f32 v205, v154, v155
    v_cvt_pk_bf16_f32 v206, v156, v157
    v_cvt_pk_bf16_f32 v207, v158, v159
    v_add3_u32 v121, v121, v200, v201
    v_add3_u32 v121, v121, v202, v203
    v_mfma_f32_32x32x16_bf16 v[160:175], v[232:235], v[56:59], v[160:175]
    ds_read_b64_tr_b16 v[228:229], v6 offset:16384
    ds_read_b64_tr_b16 v[230:231], v7 offset:16384
    v_add3_u32 v121, v121, v204, v205
    v_add3_u32 v121, v121, v206, v207
    v_xor_b32 v13, 64, v8
    ds_write_b128 v13, v[200:203]
    v_xor_b32 v14, 80, v8
    v_mfma_f32_32x32x16_bf16 v[160:175], v[236:239], v[60:63], v[160:175]
    ds_read_b64_tr_b16 v[232:233], v6 offset:32768
    ds_read_b64_tr_b16 v[234:235], v7 offset:32768
    ds_write_b128 v14, v[204:207]
    s_waitcnt lgkmcnt(8)
    v_mfma_f32_32x32x16_bf16 v[176:191], v[208:211], v[32:35], 0
    ds_read_b64_tr_b16 v[236:237], v6 offset:49152
    ds_read_b64_tr_b16 v[238:239], v7 offset:49152
    ds_read_b128 v[240:243], v9 offset:0
    ds_read_b128 v[244:247], v9 offset:1024
    ds_read_b128 v[248:251], v9 offset:2048
    ds_read_b128 v[252:255], v9 offset:3072
    v_mfma_f32_32x32x16_bf16 v[176:191], v[212:215], v[36:39], v[176:191]
    v_mfma_f32_32x32x16_bf16 v[176:191], v[216:219], v[40:43], v[176:191]
    s_waitcnt lgkmcnt(3)
    s_add_u32 s3, s67, 0
    buffer_store_dwordx4 v[240:243], v3, s[4:7], s3 offen offset:0 sc1
    s_waitcnt lgkmcnt(2)
    s_add_u32 s3, s67, 1048576
    buffer_store_dwordx4 v[244:247], v3, s[4:7], s3 offen offset:0 sc1
    v_cvt_pk_bf16_f32 v192, v160, v161
    v_cvt_pk_bf16_f32 v193, v162, v163
    v_cvt_pk_bf16_f32 v194, v164, v165
    v_mfma_f32_32x32x16_bf16 v[176:191], v[220:223], v[44:47], v[176:191]
    s_waitcnt lgkmcnt(1)
    s_add_u32 s3, s67, 2097152
    buffer_store_dwordx4 v[248:251], v3, s[4:7], s3 offen offset:0 sc1
    s_waitcnt lgkmcnt(0)
    s_add_u32 s3, s67, 3145728
    buffer_store_dwordx4 v[252:255], v3, s[4:7], s3 offen offset:0 sc1
    v_cvt_pk_bf16_f32 v195, v166, v167
    v_cvt_pk_bf16_f32 v196, v168, v169
    v_cvt_pk_bf16_f32 v197, v170, v171
    s_waitcnt lgkmcnt(4)
    v_mfma_f32_32x32x16_bf16 v[176:191], v[224:227], v[48:51], v[176:191]
    v_cvt_pk_bf16_f32 v198, v172, v173
    v_cvt_pk_bf16_f32 v199, v174, v175
    v_add3_u32 v121, v121, v192, v193
    v_mfma_f32_32x32x16_bf16 v[176:191], v[228:231], v[52:55], v[176:191]
    v_add3_u32 v121, v121, v194, v195
    v_add3_u32 v121, v121, v196, v197
    v_add3_u32 v121, v121, v198, v199
    v_mfma_f32_32x32x16_bf16 v[176:191], v[232:235], v[56:59], v[176:191]
    ds_write_b128 v8, v[192:195]
    v_xor_b32 v14, 16, v8
    ds_write_b128 v14, v[196:199]
    v_mfma_f32_32x32x16_bf16 v[176:191], v[236:239], v[60:63], v[176:191]
    s_nop 11
    v_cvt_pk_bf16_f32 v200, v176, v177
    v_cvt_pk_bf16_f32 v201, v178, v179
    v_cvt_pk_bf16_f32 v202, v180, v181
    v_cvt_pk_bf16_f32 v203, v182, v183
    v_cvt_pk_bf16_f32 v204, v184, v185
    v_cvt_pk_bf16_f32 v205, v186, v187
    v_cvt_pk_bf16_f32 v206, v188, v189
    v_cvt_pk_bf16_f32 v207, v190, v191
    v_add3_u32 v121, v121, v200, v201
    v_add3_u32 v121, v121, v202, v203
    v_add3_u32 v121, v121, v204, v205
    v_add3_u32 v121, v121, v206, v207
    v_xor_b32 v13, 64, v8
    ds_write_b128 v13, v[200:203]
    v_xor_b32 v14, 80, v8
    ds_write_b128 v14, v[204:207]
    ds_read_b128 v[240:243], v9 offset:0
    ds_read_b128 v[244:247], v9 offset:1024
    ds_read_b128 v[248:251], v9 offset:2048
    ds_read_b128 v[252:255], v9 offset:3072
    v_mov_b32 v126, v121
    s_nop 1
    v_permlane32_swap_b32 v121, v126
    v_add_u32 v121, v121, v126
    v_add_u32 v121, s63, v121
    v_lshlrev_b32 v126, 2, v1
    s_waitcnt lgkmcnt(3)
    s_add_u32 s3, s67, 0
    buffer_store_dwordx4 v[240:243], v3, s[4:7], s3 offen offset:128 sc1
    s_waitcnt lgkmcnt(2)
    s_add_u32 s3, s67, 1048576
    buffer_store_dwordx4 v[244:247], v3, s[4:7], s3 offen offset:128 sc1
    s_waitcnt lgkmcnt(1)
    s_add_u32 s3, s67, 2097152
    buffer_store_dwordx4 v[248:251], v3, s[4:7], s3 offen offset:128 sc1
    s_waitcnt lgkmcnt(0)
    s_add_u32 s3, s67, 3145728
    buffer_store_dwordx4 v[252:255], v3, s[4:7], s3 offen offset:128 sc1
    s_lshl_b32 s3, s66, 9
    s_lshl_b32 s69, s60, 7
    s_add_u32 s3, s3, s69
    s_add_u32 s3, s3, 0x130000
    s_mov_b32 exec_hi, 0
    s_waitcnt vmcnt(8)
    buffer_store_dword v121, v126, s[4:7], s3 offen sc1
    s_mov_b64 exec, -1
    s_cmp_ge_u32 s66, 112
    s_cbranch_scc1 L_Aend
    s_mul_i32 s52, s66, 0x5556
    s_lshr_b32 s52, s52, 16
    s_and_b32 s53, s52, 3
    s_lshr_b32 s54, s52, 2
    s_and_b32 s54, s54, 7
    s_barrier
    s_lshl_b32 s69, s60, 10
    s_mov_b64 s[36:37], s[8:9]
    buffer_load_dwordx4 v[4:7], v2, s[36:39], s69 offen
    v_and_b32 v8, 3, v1
    v_lshlrev_b32 v8, 7, v8
    s_and_b32 s56, s66, 0x7c
    s_lshl_b32 s56, s56, 7
    s_add_u32 s56, s56, 0x18000
    buffer_load_dwordx2 v[156:157], v8, s[4:7], s56 offen sc1
    v_and_b32 v9, 15, v1
    v_lshlrev_b32 v9, 7, v9
    s_lshl_b32 s68, s66, 11
    s_add_u32 s68, s68, 0xc0000
    buffer_load_dword v0, v9, s[4:7], s68 offen sc1
    s_lshl_b32 s3, s60, 12
    s_add_u32 s3, s3, 0x140000
    s_mov_b32 s67, 0x3f80
    s_mov_b32 s65, 1.0
    v_bfe_u32 v158, v1, 2, 1
    v_lshlrev_b32 v158, 3, v158
    v_lshrrev_b32 v10, 5, v1
    v_lshl_add_u32 v158, v10, 2, v158
    v_bfe_u32 v10, v1, 4, 1
    v_lshl_add_u32 v158, v10, 1, v158
    v_and_b32 v10, 3, v1
    v_lshlrev_b32 v10, 12, v10
    v_lshl_add_u32 v15, v158, 1, v10
    s_and_b32 s59, s52, 31
    s_lshl_b32 s59, s59, 5
    s_add_u32 s59, s59, 0x140c00
    s_add_u32 s57, s3, 0
    buffer_load_dwordx4 v[64:67], v2, s[4:7], s57 offen offset:0 sc1
    buffer_load_dwordx4 v[68:71], v2, s[4:7], s57 offen offset:1024 sc1
    buffer_load_dwordx4 v[72:75], v2, s[4:7], s57 offen offset:2048 sc1
    s_add_u32 s57, s3, 16384
    buffer_load_dwordx4 v[76:79], v2, s[4:7], s57 offen offset:0 sc1
    buffer_load_dwordx4 v[80:83], v2, s[4:7], s57 offen offset:1024 sc1
    buffer_load_dwordx4 v[84:87], v2, s[4:7], s57 offen offset:2048 sc1
    s_add_u32 s57, s3, 32768
    buffer_load_dwordx4 v[88:91], v2, s[4:7], s57 offen offset:0 sc1
    buffer_load_dwordx4 v[92:95], v2, s[4:7], s57 offen offset:1024 sc1
    buffer_load_dwordx4 v[96:99], v2, s[4:7], s57 offen offset:2048 sc1
    s_add_u32 s57, s3, 49152
    buffer_load_dwordx4 v[100:103], v2, s[4:7], s57 offen offset:0 sc1
    buffer_load_dwordx4 v[104:107], v2, s[4:7], s57 offen offset:1024 sc1
    buffer_load_dwordx4 v[108:111], v2, s[4:7], s57 offen offset:2048 sc1
    s_add_u32 s57, s59, 0
    buffer_load_dword v144, v15, s[4:7], s57 offen sc1
    s_add_u32 s57, s59, 16384
    buffer_load_dword v145, v15, s[4:7], s57 offen sc1
    s_add_u32 s57, s59, 32768
    buffer_load_dword v146, v15, s[4:7], s57 offen sc1
    s_add_u32 s57, s59, 49152
    buffer_load_dword v147, v15, s[4:7], s57 offen sc1
    v_lshrrev_b32 v10, 3, v1
    v_mul_u32_u24 v10, 3584, v10
    v_and_b32 v11, 7, v1
    v_lshl_add_u32 v10, v11, 4, v10
    s_and_b32 s58, s66, 3
    s_lshl_b32 s58, s58, 2
    s_add_u32 s58, s58, s60
    s_mul_i32 s58, s58, 114688
    s_lshr_b32 s69, s66, 2
    s_lshl_b32 s69, s69, 7
    s_add_u32 s58, s58, s69
    s_lshl_b32 s69, s60, 12
    s_mov_b64 s[36:37], s[22:23]
    s_mov_b64 s[40:41], s[24:25]
    s_add_u32 m0, s69, 32768
    s_nop 0
    buffer_load_dwordx4 v10, s[36:39], s58 offen nt lds
    s_add_u32 m0, s69, 49152
    s_nop 0
    buffer_load_dwordx4 v10, s[40:43], s58 offen nt lds
    s_add_u32 m0, s69, 33792
    s_add_u32 s58, s58, 28672
    buffer_load_dwordx4 v10, s[36:39], s58 offen nt lds
    s_add_u32 m0, s69, 50176
    s_nop 0
    buffer_load_dwordx4 v10, s[40:43], s58 offen nt lds
    s_add_u32 m0, s69, 34816
    s_add_u32 s58, s58, 28672
    buffer_load_dwordx4 v10, s[36:39], s58 offen nt lds
    s_add_u32 m0, s69, 51200
    s_nop 0
    buffer_load_dwordx4 v10, s[40:43], s58 offen nt lds
    s_add_u32 m0, s69, 35840
    s_add_u32 s58, s58, 28672
    buffer_load_dwordx4 v10, s[36:39], s58 offen nt lds
    s_add_u32 m0, s69, 52224
    s_nop 0
    buffer_load_dwordx4 v10, s[40:43], s58 offen nt lds
    v_lshrrev_b32 v11, 4, v1
    v_and_b32 v12, 15, v1
    v_lshlrev_b32 v13, 2, v11
    v_xor_b32 v13, v13, v12
    v_lshlrev_b32 v13, 4, v13
    v_lshl_add_u32 v13, v11, 10, v13
    s_lshl_b32 s58, s66, 14
    s_lshl_b32 s69, s60, 8
    s_add_u32 s58, s58, s69
    s_lshl_b32 s69, s60, 12
    s_mov_b64 s[44:45], s[26:27]
    s_add_u32 m0, s69, 65536
    s_nop 0
    buffer_load_dwordx4 v13, s[44:47], s58 offen nt lds
    s_add_u32 m0, s69, 66560
    s_add_u32 s58, s58, 4096
    buffer_load_dwordx4 v13, s[44:47], s58 offen nt lds
    s_add_u32 m0, s69, 67584
    s_add_u32 s58, s58, 4096
    buffer_load_dwordx4 v13, s[44:47], s58 offen nt lds
    s_add_u32 m0, s69, 68608
    s_add_u32 s58, s58, 4096
    buffer_load_dwordx4 v13, s[44:47], s58 offen nt lds
    s_waitcnt vmcnt(26)
    v_max_u32 v14, v67, v71
    s_waitcnt vmcnt(24)
    v_max3_u32 v14, v14, v75, v79
    s_waitcnt vmcnt(22)
    v_max3_u32 v14, v14, v83, v87
    s_waitcnt vmcnt(20)
    v_max3_u32 v14, v14, v91, v95
    s_waitcnt vmcnt(18)
    v_max3_u32 v14, v14, v99, v103
    s_waitcnt vmcnt(16)
    v_max3_u32 v14, v14, v107, v111
    s_waitcnt vmcnt(12)
    v_max3_u32 v14, v14, v144, v145
    v_max3_u32 v14, v14, v146, v147
    v_cmp_eq_u32 vcc, -1, v14
    s_cbranch_vccz O_22
P_23:
    s_add_u32 s57, s3, 0
    buffer_load_dwordx4 v[64:67], v2, s[4:7], s57 offen offset:0 sc1
    buffer_load_dwordx4 v[68:71], v2, s[4:7], s57 offen offset:1024 sc1
    buffer_load_dwordx4 v[72:75], v2, s[4:7], s57 offen offset:2048 sc1
    s_add_u32 s57, s3, 16384
    buffer_load_dwordx4 v[76:79], v2, s[4:7], s57 offen offset:0 sc1
    buffer_load_dwordx4 v[80:83], v2, s[4:7], s57 offen offset:1024 sc1
    buffer_load_dwordx4 v[84:87], v2, s[4:7], s57 offen offset:2048 sc1
    s_add_u32 s57, s3, 32768
    buffer_load_dwordx4 v[88:91], v2, s[4:7], s57 offen offset:0 sc1
    buffer_load_dwordx4 v[92:95], v2, s[4:7], s57 offen offset:1024 sc1
    buffer_load_dwordx4 v[96:99], v2, s[4:7], s57 offen offset:2048 sc1
    s_add_u32 s57, s3, 49152
    buffer_load_dwordx4 v[100:103], v2, s[4:7], s57 offen offset:0 sc1
    buffer_load_dwordx4 v[104:107], v2, s[4:7], s57 offen offset:1024 sc1
    buffer_load_dwordx4 v[108:111], v2, s[4:7], s57 offen offset:2048 sc1
    s_add_u32 s57, s59, 0
    buffer_load_dword v144, v15, s[4:7], s57 offen sc1
    s_add_u32 s57, s59, 16384
    buffer_load_dword v145, v15, s[4:7], s57 offen sc1
    s_add_u32 s57, s59, 32768
    buffer_load_dword v146, v15, s[4:7], s57 offen sc1
    s_add_u32 s57, s59, 49152
    buffer_load_dword v147, v15, s[4:7], s57 offen sc1
    s_waitcnt vmcnt(14)
    v_max_u32 v14, v67, v71
    s_waitcnt vmcnt(12)
    v_max3_u32 v14, v14, v75, v79
    s_waitcnt vmcnt(10)
    v_max3_u32 v14, v14, v83, v87
    s_waitcnt vmcnt(8)
    v_max3_u32 v14, v14, v91, v95
    s_waitcnt vmcnt(6)
    v_max3_u32 v14, v14, v99, v103
    s_waitcnt vmcnt(4)
    v_max3_u32 v14, v14, v107, v111
    s_waitcnt vmcnt(0)
    v_max3_u32 v14, v14, v144, v145
    v_max3_u32 v14, v14, v146, v147
    v_cmp_eq_u32 vcc, -1, v14
    s_cbranch_vccz Q_24
    s_add_u32 s64, s64, 1
    s_cmp_gt_u32 s64, 200000
    s_cbranch_scc1 Q_24
    s_sleep 4
    s_branch P_23
Q_24:
O_22:
    v_dot2_f32_bf16 v112, v64, s67, 0
    v_dot2_f32_bf16 v113, v64, s65, 0
    v_dot2_f32_bf16 v114, v65, s67, 0
    v_dot2_f32_bf16 v115, v65, s65, 0
    v_dot2_f32_bf16 v116, v66, s67, 0
    v_dot2_f32_bf16 v117, v66, s65, 0
    v_dot2_f32_bf16 v118, v67, s67, 0
    v_dot2_f32_bf16 v119, v67, s65, 0
    v_dot2_f32_bf16 v128, v68, s67, 0
    v_dot2_f32_bf16 v129, v68, s65, 0
    v_dot2_f32_bf16 v130, v69, s67, 0
    v_dot2_f32_bf16 v131, v69, s65, 0
    v_dot2_f32_bf16 v132, v70, s67, 0
    v_dot2_f32_bf16 v133, v70, s65, 0
    v_dot2_f32_bf16 v134, v71, s67, 0
    v_dot2_f32_bf16 v135, v71, s65, 0
    v_dot2_f32_bf16 v120, v72, s67, 1.0
    v_dot2_f32_bf16 v121, v72, s65, 1.0
    v_dot2_f32_bf16 v122, v73, s67, 1.0
    v_dot2_f32_bf16 v123, v73, s65, 1.0
    v_dot2_f32_bf16 v124, v74, s67, 1.0
    v_dot2_f32_bf16 v125, v74, s65, 1.0
    v_dot2_f32_bf16 v126, v75, s67, 1.0
    v_dot2_f32_bf16 v127, v75, s65, 1.0
    v_dot2c_f32_bf16 v112, s67, v76
    v_dot2c_f32_bf16 v113, s65, v76
    v_dot2c_f32_bf16 v114, s67, v77
    v_dot2c_f32_bf16 v115, s65, v77
    v_dot2c_f32_bf16 v116, s67, v78
    v_dot2c_f32_bf16 v117, s65, v78
    v_dot2c_f32_bf16 v118, s67, v79
    v_dot2c_f32_bf16 v119, s65, v79
    v_dot2c_f32_bf16 v128, s67, v80
    v_dot2c_f32_bf16 v129, s65, v80
    v_dot2c_f32_bf16 v130, s67, v81
    v_dot2c_f32_bf16 v131, s65, v81
    v_dot2c_f32_bf16 v132, s67, v82
    v_dot2c_f32_bf16 v133, s65, v82
    v_dot2c_f32_bf16 v134, s67, v83
    v_dot2c_f32_bf16 v135, s65, v83
    v_dot2c_f32_bf16 v120, s67, v84
    v_dot2c_f32_bf16 v121, s65, v84
    v_dot2c_f32_bf16 v122, s67, v85
    v_dot2c_f32_bf16 v123, s65, v85
    v_dot2c_f32_bf16 v124, s67, v86
    v_dot2c_f32_bf16 v125, s65, v86
    v_dot2c_f32_bf16 v126, s67, v87
    v_dot2c_f32_bf16 v127, s65, v87
    v_dot2c_f32_bf16 v112, s67, v88
    v_dot2c_f32_bf16 v113, s65, v88
    v_dot2c_f32_bf16 v114, s67, v89
    v_dot2c_f32_bf16 v115, s65, v89
    v_dot2c_f32_bf16 v116, s67, v90
    v_dot2c_f32_bf16 v117, s65, v90
    v_dot2c_f32_bf16 v118, s67, v91
    v_dot2c_f32_bf16 v119, s65, v91
    v_dot2c_f32_bf16 v128, s67, v92
    v_dot2c_f32_bf16 v129, s65, v92
    v_dot2c_f32_bf16 v130, s67, v93
    v_dot2c_f32_bf16 v131, s65, v93
    v_dot2c_f32_bf16 v132, s67, v94
    v_dot2c_f32_bf16 v133, s65, v94
    v_dot2c_f32_bf16 v134, s67, v95
    v_dot2c_f32_bf16 v135, s65, v95
    v_dot2c_f32_bf16 v120, s67, v96
    v_dot2c_f32_bf16 v121, s65, v96
    v_dot2c_f32_bf16 v122, s67, v97
    v_dot2c_f32_bf16 v123, s65, v97
    v_dot2c_f32_bf16 v124, s67, v98
    v_dot2c_f32_bf16 v125, s65, v98
    v_dot2c_f32_bf16 v126, s67, v99
    v_dot2c_f32_bf16 v127, s65, v99
    v_dot2c_f32_bf16 v112, s67, v100
    v_dot2c_f32_bf16 v113, s65, v100
    v_dot2c_f32_bf16 v114, s67, v101
    v_dot2c_f32_bf16 v115, s65, v101
    v_dot2c_f32_bf16 v116, s67, v102
    v_dot2c_f32_bf16 v117, s65, v102
    v_dot2c_f32_bf16 v118, s67, v103
    v_dot2c_f32_bf16 v119, s65, v103
    v_dot2c_f32_bf16 v128, s67, v104
    v_dot2c_f32_bf16 v129, s65, v104
    v_dot2c_f32_bf16 v130, s67, v105
    v_dot2c_f32_bf16 v131, s65, v105
    v_dot2c_f32_bf16 v132, s67, v106
    v_dot2c_f32_bf16 v133, s65, v106
    v_dot2c_f32_bf16 v134, s67, v107
    v_dot2c_f32_bf16 v135, s65, v107
    v_dot2c_f32_bf16 v120, s67, v108
    v_dot2c_f32_bf16 v121, s65, v108
    v_dot2c_f32_bf16 v122, s67, v109
    v_dot2c_f32_bf16 v123, s65, v109
    v_dot2c_f32_bf16 v124, s67, v110
    v_dot2c_f32_bf16 v125, s65, v110
    v_dot2c_f32_bf16 v126, s67, v111
    v_dot2c_f32_bf16 v127, s65, v111
    v_cmp_ne_u32 vcc, s63, v156
    s_cbranch_vccz K_25
P_26:
    buffer_load_dwordx2 v[156:157], v8, s[4:7], s56 offen sc1
    s_waitcnt vmcnt(0)
    v_cmp_ne_u32 vcc, s63, v156
    s_cbranch_vccz Q_27
    s_add_u32 s64, s64, 1
    s_cmp_gt_u32 s64, 200000
    s_cbranch_scc1 Q_27
    s_sleep 4
    s_branch P_26
Q_27:
K_25:
    s_getreg_b32 s55, hwreg(HW_REG_XCC_ID, 0, 4)
    v_cmp_ne_u32 vcc, s55, v157
    s_nop 0
    s_cmp_eq_u64 vcc, 0
    s_cselect_b32 s55, 1, 0
    v_dot2_f32_bf16 v98, v144, s67, 0
    v_dot2_f32_bf16 v99, v144, s65, 0
    v_dot2_f32_bf16 v98, v145, s67, v98
    v_dot2_f32_bf16 v99, v145, s65, v99
    v_dot2_f32_bf16 v98, v146, s67, v98
    v_dot2_f32_bf16 v99, v146, s65, v99
    v_dot2_f32_bf16 v98, v147, s67, v98
    v_dot2_f32_bf16 v99, v147, s65, v99
    v_lshlrev_b32 v136, 16, v4
    v_and_b32 v137, 0xffff0000, v4
    v_lshlrev_b32 v138, 16, v5
    v_and_b32 v139, 0xffff0000, v5
    v_lshlrev_b32 v140, 16, v6
    v_and_b32 v141, 0xffff0000, v6
    v_lshlrev_b32 v142, 16, v7
    v_and_b32 v143, 0xffff0000, v7
    v_bfe_u32 v12, v1, 2, 2
    v_and_b32 v14, 3, v1
    s_mul_i32 s3, s60, 1088
    v_add_u32 v100, s3, v2
    v_mul_u32_u24 v101, 1088, v14
    v_lshl_add_u32 v101, v11, 4, v101
    s_and_b32 s3, s66, 3
    s_lshl_b32 s3, s3, 8
    v_add_u32 v101, s3, v101
    v_lshlrev_b32 v102, 4, v14
    v_lshl_add_u32 v102, v11, 6, v102
    v_lshl_add_u32 v103, v12, 9, v102
    v_lshl_add_u32 v104, v12, 8, v102
    v_lshlrev_b32 v105, 5, v1
    s_lshl_b32 s3, s60, 11
    s_add_u32 s3, s3, 16384
    v_add_u32 v105, s3, v105
    v_cmp_eq_u32 vcc, 0, v12
    s_nop 1
    v_cndmask_b32 v106, 0, -1, vcc
    v_cmp_eq_u32 vcc, 1, v12
    s_nop 1
    v_cndmask_b32 v107, 0, -1, vcc
    v_cmp_eq_u32 vcc, 2, v12
    s_nop 1
    v_cndmask_b32 v108, 0, -1, vcc
    v_cmp_eq_u32 vcc, 3, v12
    s_nop 1
    v_cndmask_b32 v109, 0, -1, vcc
    v_lshl_add_u32 v10, v11, 3, v12
    v_lshlrev_b32 v10, 7, v10
    v_lshl_add_u32 v10, v14, 3, v10
    s_lshl_b32 s3, s60, 5
    s_add_u32 s3, s3, 32768
    v_add_u32 v10, s3, v10
    v_lshl_add_u32 v15, v11, 2, v12
    v_lshlrev_b32 v15, 8, v15
    v_lshl_add_u32 v15, v12, 6, v15
    v_lshl_add_u32 v15, v14, 4, v15
    s_lshl_b32 s3, s60, 12
    s_add_u32 s3, s3, 65536
    v_add_u32 v15, s3, v15
    s_waitcnt vmcnt(4)
    s_barrier
    ds_read_b64_tr_b16 v[16:17], v10 offset:0
    ds_read_b64_tr_b16 v[18:19], v10 offset:512
    ds_read_b64_tr_b16 v[20:21], v10 offset:4096
    ds_read_b64_tr_b16 v[22:23], v10 offset:4608
    ds_read_b64_tr_b16 v[24:25], v10 offset:8192
    ds_read_b64_tr_b16 v[26:27], v10 offset:8704
    ds_read_b64_tr_b16 v[28:29], v10 offset:12288
    ds_read_b64_tr_b16 v[30:31], v10 offset:12800
    ds_read_b64_tr_b16 v[32:33], v10 offset:16384
    ds_read_b64_tr_b16 v[34:35], v10 offset:16896
    ds_read_b64_tr_b16 v[36:37], v10 offset:20480
    ds_read_b64_tr_b16 v[38:39], v10 offset:20992
    ds_read_b64_tr_b16 v[40:41], v10 offset:24576
    ds_read_b64_tr_b16 v[42:43], v10 offset:25088
    ds_read_b64_tr_b16 v[44:45], v10 offset:28672
    ds_read_b64_tr_b16 v[46:47], v10 offset:29184
    s_waitcnt vmcnt(0)
    ds_read_b64_tr_b16 v[48:49], v15 offset:0
    ds_read_b64_tr_b16 v[50:51], v15 offset:8
    v_xor_b32 v13, 64, v15
    ds_read_b64_tr_b16 v[52:53], v13 offset:0
    ds_read_b64_tr_b16 v[54:55], v13 offset:8
    v_xor_b32 v13, 128, v15
    ds_read_b64_tr_b16 v[56:57], v13 offset:0
    ds_read_b64_tr_b16 v[58:59], v13 offset:8
    v_xor_b32 v13, 192, v15
    ds_read_b64_tr_b16 v[60:61], v13 offset:0
    ds_read_b64_tr_b16 v[62:63], v13 offset:8
    s_lshl_b32 s3, s60, 10
    s_add_u32 s3, s3, 0x150000
    s_mov_b32 s59, 0x1c00
    v_and_b32 v4, 7, v1
    v_lshlrev_b32 v4, 7, v4
P_28:
    buffer_load_dword v5, v4, s[4:7], s59 offen sc1
    s_waitcnt vmcnt(0)
    v_cmp_ne_u32 vcc, s63, v5
    s_cbranch_vccz Q_29
    s_add_u32 s64, s64, 1
    s_cmp_gt_u32 s64, 200000
    s_cbranch_scc1 Q_29
    s_sleep 1
    s_branch P_28
Q_29:
P_30:
    s_add_u32 s69, s3, 0
    buffer_load_dwordx4 v[176:179], v2, s[4:7], s69 offen sc1
    s_add_u32 s69, s3, 4096
    buffer_load_dwordx4 v[180:183], v2, s[4:7], s69 offen sc1
    s_add_u32 s69, s3, 8192
    buffer_load_dwordx4 v[184:187], v2, s[4:7], s69 offen sc1
    s_add_u32 s69, s3, 12288
    buffer_load_dwordx4 v[188:191], v2, s[4:7], s69 offen sc1
    s_add_u32 s69, s3, 16384
    buffer_load_dwordx4 v[192:195], v2, s[4:7], s69 offen sc1
    s_add_u32 s69, s3, 20480
    buffer_load_dwordx4 v[196:199], v2, s[4:7], s69 offen sc1
    s_add_u32 s69, s3, 24576
    buffer_load_dwordx4 v[200:203], v2, s[4:7], s69 offen sc1
    s_add_u32 s69, s3, 28672
    buffer_load_dwordx4 v[204:207], v2, s[4:7], s69 offen sc1
    s_add_u32 s69, s3, 32768
    buffer_load_dwordx4 v[208:211], v2, s[4:7], s69 offen sc1
    s_add_u32 s69, s3, 36864
    buffer_load_dwordx4 v[212:215], v2, s[4:7], s69 offen sc1
    s_add_u32 s69, s3, 40960
    buffer_load_dwordx4 v[216:219], v2, s[4:7], s69 offen sc1
    s_add_u32 s69, s3, 45056
    buffer_load_dwordx4 v[220:223], v2, s[4:7], s69 offen sc1
    s_add_u32 s69, s3, 49152
    buffer_load_dwordx4 v[224:227], v2, s[4:7], s69 offen sc1
    s_add_u32 s69, s3, 53248
    buffer_load_dwordx4 v[228:231], v2, s[4:7], s69 offen sc1
    s_add_u32 s69, s3, 57344
    buffer_load_dwordx4 v[232:235], v2, s[4:7], s69 offen sc1
    s_add_u32 s69, s3, 61440
    buffer_load_dwordx4 v[236:239], v2, s[4:7], s69 offen sc1
    s_waitcnt vmcnt(15)
    v_dot2_f32_bf16 v144, v176, s67, 0
    v_dot2_f32_bf16 v145, v176, s65, 0
    v_dot2_f32_bf16 v146, v177, s67, 0
    v_dot2_f32_bf16 v147, v177, s65, 0
    v_dot2_f32_bf16 v148, v178, s67, 0
    v_dot2_f32_bf16 v149, v178, s65, 0
    v_dot2_f32_bf16 v150, v179, s67, 0
    v_dot2_f32_bf16 v151, v179, s65, 0
    s_waitcnt vmcnt(14)
    v_dot2c_f32_bf16 v144, s67, v180
    v_dot2c_f32_bf16 v145, s65, v180
    v_dot2c_f32_bf16 v146, s67, v181
    v_dot2c_f32_bf16 v147, s65, v181
    v_dot2c_f32_bf16 v148, s67, v182
    v_dot2c_f32_bf16 v149, s65, v182
    v_dot2c_f32_bf16 v150, s67, v183
    v_dot2c_f32_bf16 v151, s65, v183
    v_max_u32 v13, v179, v183
    s_waitcnt vmcnt(13)
    v_dot2c_f32_bf16 v144, s67, v184
    v_dot2c_f32_bf16 v145, s65, v184
    v_dot2c_f32_bf16 v146, s67, v185
    v_dot2c_f32_bf16 v147, s65, v185
    v_dot2c_f32_bf16 v148, s67, v186
    v_dot2c_f32_bf16 v149, s65, v186
    v_dot2c_f32_bf16 v150, s67, v187
    v_dot2c_f32_bf16 v151, s65, v187
    s_waitcnt vmcnt(12)
    v_dot2c_f32_bf16 v144, s67, v188
    v_dot2c_f32_bf16 v145, s65, v188
    v_dot2c_f32_bf16 v146, s67, v189
    v_dot2c_f32_bf16 v147, s65, v189
    v_dot2c_f32_bf16 v148, s67, v190
    v_dot2c_f32_bf16 v149, s65, v190
    v_dot2c_f32_bf16 v150, s67, v191
    v_dot2c_f32_bf16 v151, s65, v191
    v_max3_u32 v13, v13, v187, v191
    s_waitcnt vmcnt(11)
    v_dot2c_f32_bf16 v144, s67, v192
    v_dot2c_f32_bf16 v145, s65, v192
    v_dot2c_f32_bf16 v146, s67, v193
    v_dot2c_f32_bf16 v147, s65, v193
    v_dot2c_f32_bf16 v148, s67, v194
    v_dot2c_f32_bf16 v149, s65, v194
    v_dot2c_f32_bf16 v150, s67, v195
    v_dot2c_f32_bf16 v151, s65, v195
    s_waitcnt vmcnt(10)
    v_dot2c_f32_bf16 v144, s67, v196
    v_dot2c_f32_bf16 v145, s65, v196
    v_dot2c_f32_bf16 v146, s67, v197
    v_dot2c_f32_bf16 v147, s65, v197
    v_dot2c_f32_bf16 v148, s67, v198
    v_dot2c_f32_bf16 v149, s65, v198
    v_dot2c_f32_bf16 v150, s67, v199
    v_dot2c_f32_bf16 v151, s65, v199
    v_max3_u32 v13, v13, v195, v199
    s_waitcnt vmcnt(9)
    v_dot2c_f32_bf16 v144, s67, v200
    v_dot2c_f32_bf16 v145, s65, v200
    v_dot2c_f32_bf16 v146, s67, v201
    v_dot2c_f32_bf16 v147, s65, v201
    v_dot2c_f32_bf16 v148, s67, v202
    v_dot2c_f32_bf16 v149, s65, v202
    v_dot2c_f32_bf16 v150, s67, v203
    v_dot2c_f32_bf16 v151, s65, v203
    s_waitcnt vmcnt(8)
    v_dot2c_f32_bf16 v144, s67, v204
    v_dot2c_f32_bf16 v145, s65, v204
    v_dot2c_f32_bf16 v146, s67, v205
    v_dot2c_f32_bf16 v147, s65, v205
    v_dot2c_f32_bf16 v148, s67, v206
    v_dot2c_f32_bf16 v149, s65, v206
    v_dot2c_f32_bf16 v150, s67, v207
    v_dot2c_f32_bf16 v151, s65, v207
    v_max3_u32 v13, v13, v203, v207
    s_waitcnt vmcnt(7)
    v_dot2c_f32_bf16 v144, s67, v208
    v_dot2c_f32_bf16 v145, s65, v208
    v_dot2c_f32_bf16 v146, s67, v209
    v_dot2c_f32_bf16 v147, s65, v209
    v_dot2c_f32_bf16 v148, s67, v210
    v_dot2c_f32_bf16 v149, s65, v210
    v_dot2c_f32_bf16 v150, s67, v211
    v_dot2c_f32_bf16 v151, s65, v211
    s_waitcnt vmcnt(6)
    v_dot2c_f32_bf16 v144, s67, v212
    v_dot2c_f32_bf16 v145, s65, v212
    v_dot2c_f32_bf16 v146, s67, v213
    v_dot2c_f32_bf16 v147, s65, v213
    v_dot2c_f32_bf16 v148, s67, v214
    v_dot2c_f32_bf16 v149, s65, v214
    v_dot2c_f32_bf16 v150, s67, v215
    v_dot2c_f32_bf16 v151, s65, v215
    v_max3_u32 v13, v13, v211, v215
    s_waitcnt vmcnt(5)
    v_dot2c_f32_bf16 v144, s67, v216
    v_dot2c_f32_bf16 v145, s65, v216
    v_dot2c_f32_bf16 v146, s67, v217
    v_dot2c_f32_bf16 v147, s65, v217
    v_dot2c_f32_bf16 v148, s67, v218
    v_dot2c_f32_bf16 v149, s65, v218
    v_dot2c_f32_bf16 v150, s67, v219
    v_dot2c_f32_bf16 v151, s65, v219
    s_waitcnt vmcnt(4)
    v_dot2c_f32_bf16 v144, s67, v220
    v_dot2c_f32_bf16 v145, s65, v220
    v_dot2c_f32_bf16 v146, s67, v221
    v_dot2c_f32_bf16 v147, s65, v221
    v_dot2c_f32_bf16 v148, s67, v222
    v_dot2c_f32_bf16 v149, s65, v222
    v_dot2c_f32_bf16 v150, s67, v223
    v_dot2c_f32_bf16 v151, s65, v223
    v_max3_u32 v13, v13, v219, v223
    s_waitcnt vmcnt(3)
    v_dot2c_f32_bf16 v144, s67, v224
    v_dot2c_f32_bf16 v145, s65, v224
    v_dot2c_f32_bf16 v146, s67, v225
    v_dot2c_f32_bf16 v147, s65, v225
    v_dot2c_f32_bf16 v148, s67, v226
    v_dot2c_f32_bf16 v149, s65, v226
    v_dot2c_f32_bf16 v150, s67, v227
    v_dot2c_f32_bf16 v151, s65, v227
    s_waitcnt vmcnt(2)
    v_dot2c_f32_bf16 v144, s67, v228
    v_dot2c_f32_bf16 v145, s65, v228
    v_dot2c_f32_bf16 v146, s67, v229
    v_dot2c_f32_bf16 v147, s65, v229
    v_dot2c_f32_bf16 v148, s67, v230
    v_dot2c_f32_bf16 v149, s65, v230
    v_dot2c_f32_bf16 v150, s67, v231
    v_dot2c_f32_bf16 v151, s65, v231
    v_max3_u32 v13, v13, v227, v231
    s_waitcnt vmcnt(1)
    v_dot2c_f32_bf16 v144, s67, v232
    v_dot2c_f32_bf16 v145, s65, v232
    v_dot2c_f32_bf16 v146, s67, v233
    v_dot2c_f32_bf16 v147, s65, v233
    v_dot2c_f32_bf16 v148, s67, v234
    v_dot2c_f32_bf16 v149, s65, v234
    v_dot2c_f32_bf16 v150, s67, v235
    v_dot2c_f32_bf16 v151, s65, v235
    s_waitcnt vmcnt(0)
    v_dot2c_f32_bf16 v144, s67, v236
    v_dot2c_f32_bf16 v145, s65, v236
    v_dot2c_f32_bf16 v146, s67, v237
    v_dot2c_f32_bf16 v147, s65, v237
    v_dot2c_f32_bf16 v148, s67, v238
    v_dot2c_f32_bf16 v149, s65, v238
    v_dot2c_f32_bf16 v150, s67, v239
    v_dot2c_f32_bf16 v151, s65, v239
    v_max3_u32 v13, v13, v235, v239
    v_cmp_eq_u32 vcc, -1, v13
    s_cbranch_vccz Q_31
    s_add_u32 s64, s64, 1
    s_cmp_gt_u32 s64, 200000
    s_cbranch_scc1 Q_31
    s_sleep 1
    s_branch P_30
Q_31:
    v_pk_fma_f32 v[136:137], v[112:113], v[144:145], v[136:137]
    v_pk_fma_f32 v[138:139], v[114:115], v[146:147], v[138:139]
    v_pk_fma_f32 v[140:141], v[116:117], v[148:149], v[140:141]
    v_pk_fma_f32 v[142:143], v[118:119], v[150:151], v[142:143]
    v_pk_mul_f32 v[152:153], v[136:137], v[136:137]
    v_pk_add_f32 v[154:155], v[136:137], v[138:139]
    v_pk_fma_f32 v[152:153], v[138:139], v[138:139], v[152:153]
    v_pk_fma_f32 v[152:153], v[140:141], v[140:141], v[152:153]
    v_pk_add_f32 v[154:155], v[154:155], v[140:141]
    v_pk_fma_f32 v[152:153], v[142:143], v[142:143], v[152:153]
    v_pk_add_f32 v[154:155], v[154:155], v[142:143]
    v_add_f32 v152, v152, v153
    v_add_f32 v153, v154, v155
    ds_write_b128 v105, v[136:139]
    ds_write_b128 v105, v[140:143] offset:16
    v_add_f32_dpp v152, v152, v152 row_ror:1 row_mask:0xf bank_mask:0xf
    v_add_f32_dpp v153, v153, v153 row_ror:1 row_mask:0xf bank_mask:0xf
    s_nop 0
    v_add_f32_dpp v152, v152, v152 row_ror:2 row_mask:0xf bank_mask:0xf
    v_add_f32_dpp v153, v153, v153 row_ror:2 row_mask:0xf bank_mask:0xf
    s_nop 0
    v_add_f32_dpp v152, v152, v152 row_ror:4 row_mask:0xf bank_mask:0xf
    v_add_f32_dpp v153, v153, v153 row_ror:4 row_mask:0xf bank_mask:0xf
    s_nop 0
    v_add_f32_dpp v152, v152, v152 row_ror:8 row_mask:0xf bank_mask:0xf
    v_add_f32_dpp v153, v153, v153 row_ror:8 row_mask:0xf bank_mask:0xf
    v_mov_b32 v154, v152
    v_mov_b32 v155, v153
    s_nop 0
    v_permlane16_swap_b32 v152, v154
    v_permlane16_swap_b32 v153, v155
    v_add_f32 v152, v152, v154
    v_add_f32 v153, v153, v155
    v_mov_b32 v154, v152
    v_mov_b32 v155, v153
    s_nop 0
    v_permlane32_swap_b32 v152, v154
    v_permlane32_swap_b32 v153, v155
    v_add_f32 v152, v152, v154
    v_add_f32 v153, v153, v155
    v_mul_f32 v154, 0x3b000000, v153
    v_mul_f32 v152, 0x3b000000, v152
    v_fma_f32 v152, -v154, v154, v152
    v_max_f32 v152, 0, v152
    v_add_f32 v152, 0x3727c5ac, v152
    v_rsq_f32 v156, v152
    s_nop 0
    v_mul_f32 v154, v154, v156
    v_sub_f32 v154, 0, v154
    v_pk_fma_f32 v[144:145], v[136:137], v[156:157], v[154:155] op_sel_hi:[1,0,0]
    v_pk_fma_f32 v[146:147], v[138:139], v[156:157], v[154:155] op_sel_hi:[1,0,0]
    v_pk_fma_f32 v[148:149], v[140:141], v[156:157], v[154:155] op_sel_hi:[1,0,0]
    v_pk_fma_f32 v[150:151], v[142:143], v[156:157], v[154:155] op_sel_hi:[1,0,0]
    v_pk_fma_f32 v[144:145], v[144:145], v[120:121], v[128:129]
    v_pk_fma_f32 v[146:147], v[146:147], v[122:123], v[130:131]
    v_pk_fma_f32 v[148:149], v[148:149], v[124:125], v[132:133]
    v_pk_fma_f32 v[150:151], v[150:151], v[126:127], v[134:135]
    v_cvt_pk_bf16_f32 v152, v144, v145
    v_cvt_pk_bf16_f32 v153, v146, v147
    v_cvt_pk_bf16_f32 v154, v148, v149
    v_cvt_pk_bf16_f32 v155, v150, v151
    ds_write_b128 v100, v[152:155]
    s_waitcnt lgkmcnt(0)
    s_barrier
    ds_read_b128 v[64:67], v101 offset:0
    ds_read_b128 v[68:71], v101 offset:64
    ds_read_b128 v[72:75], v101 offset:128
    ds_read_b128 v[76:79], v101 offset:192
    v_bfe_u32 v170, v1, 2, 1
    v_cmp_eq_u32 vcc, 0, v170
    v_lshl_add_u32 v170, v170, 8, v102
    v_mov_b32 v171, s63
    s_and_b32 s57, s66, 0x7c
    s_add_u32 s57, s57, s60
    s_lshl_b32 s57, s57, 2
    s_and_b32 s69, s66, 3
    s_add_u32 s57, s57, s69
    s_lshl_b32 s57, s57, 9
    s_add_u32 s57, s57, 0xc0000
    s_waitcnt lgkmcnt(3)
    v_mfma_f32_16x16x32_bf16 v[160:163], v[16:19], v[64:67], 0
    v_mfma_f32_16x16x32_bf16 v[164:167], v[32:35], v[64:67], 0
    s_waitcnt lgkmcnt(2)
    v_mfma_f32_16x16x32_bf16 v[160:163], v[20:23], v[68:71], v[160:163]
    v_mfma_f32_16x16x32_bf16 v[164:167], v[36:39], v[68:71], v[164:167]
    s_waitcnt lgkmcnt(1)
    v_mfma_f32_16x16x32_bf16 v[160:163], v[24:27], v[72:75], v[160:163]
    v_mfma_f32_16x16x32_bf16 v[164:167], v[40:43], v[72:75], v[164:167]
    s_waitcnt lgkmcnt(0)
    v_mfma_f32_16x16x32_bf16 v[160:163], v[28:31], v[76:79], v[160:163]
    v_mfma_f32_16x16x32_bf16 v[164:167], v[44:47], v[76:79], v[164:167]
    s_lshl_b32 s3, s66, 12
    s_lshl_b32 s69, s60, 10
    s_add_u32 s3, s3, s69
    s_add_u32 s3, s3, 0x180000
    s_nop 2
    v_cvt_pk_bf16_f32 v80, v160, v161
    v_cvt_pk_bf16_f32 v81, v162, v163
    v_cvt_pk_bf16_f32 v82, v164, v165
    v_cvt_pk_bf16_f32 v83, v166, v167
    v_mov_b32 v152, v82
    v_cndmask_b32 v153, v83, v171, vcc
    v_cndmask_b32 v154, v171, v80, vcc
    v_mov_b32 v155, v81
    s_mov_b32 exec_lo, 0xff00ff
    s_mov_b32 exec_hi, 0xff00ff
    s_cmp_eq_u32 s55, 0
    s_cbranch_scc1 G_32
    buffer_store_dwordx4 v[152:155], v170, s[4:7], s57 offen
    s_branch G_33
G_32:
    buffer_store_dwordx4 v[152:155], v170, s[4:7], s57 offen sc1
G_33:
    s_mov_b64 exec, -1
P_34:
    buffer_load_dwordx4 v[72:75], v103, s[4:7], s68 offen sc1
    buffer_load_dwordx4 v[76:79], v103, s[4:7], s68 offen offset:256 sc1
    s_waitcnt vmcnt(0)
    v_xor_b32 v13, s63, v73
    v_bitop3_b32 v13, v13, v78, s63 bitop3:0xf6
    v_cmp_ne_u32 vcc, 0, v13
    s_cbranch_vccz Q_35
    s_add_u32 s64, s64, 1
    s_cmp_gt_u32 s64, 200000
    s_cbranch_scc1 Q_35
    s_branch P_34
Q_35:
    v_lshlrev_b32 v64, 16, v74
    v_and_b32 v65, 0xffff0000, v74
    v_lshlrev_b32 v66, 16, v75
    v_and_b32 v67, 0xffff0000, v75
    v_lshlrev_b32 v68, 16, v76
    v_and_b32 v69, 0xffff0000, v76
    v_lshlrev_b32 v70, 16, v77
    v_and_b32 v71, 0xffff0000, v77
    v_add_f32_dpp v64, v64, v64 row_ror:4 row_mask:0xf bank_mask:0xf
    v_add_f32_dpp v65, v65, v65 row_ror:4 row_mask:0xf bank_mask:0xf
    v_add_f32_dpp v66, v66, v66 row_ror:4 row_mask:0xf bank_mask:0xf
    v_add_f32_dpp v67, v67, v67 row_ror:4 row_mask:0xf bank_mask:0xf
    v_add_f32_dpp v68, v68, v68 row_ror:4 row_mask:0xf bank_mask:0xf
    v_add_f32_dpp v69, v69, v69 row_ror:4 row_mask:0xf bank_mask:0xf
    v_add_f32_dpp v70, v70, v70 row_ror:4 row_mask:0xf bank_mask:0xf
    v_add_f32_dpp v71, v71, v71 row_ror:4 row_mask:0xf bank_mask:0xf
    v_add_f32_dpp v64, v64, v64 row_ror:8 row_mask:0xf bank_mask:0xf
    v_add_f32_dpp v65, v65, v65 row_ror:8 row_mask:0xf bank_mask:0xf
    v_add_f32_dpp v66, v66, v66 row_ror:8 row_mask:0xf bank_mask:0xf
    v_add_f32_dpp v67, v67, v67 row_ror:8 row_mask:0xf bank_mask:0xf
    v_add_f32_dpp v68, v68, v68 row_ror:8 row_mask:0xf bank_mask:0xf
    v_add_f32_dpp v69, v69, v69 row_ror:8 row_mask:0xf bank_mask:0xf
    v_add_f32_dpp v70, v70, v70 row_ror:8 row_mask:0xf bank_mask:0xf
    v_add_f32_dpp v71, v71, v71 row_ror:8 row_mask:0xf bank_mask:0xf
    v_mul_f32 v64, 0xbfb8aa3b, v64
    v_mul_f32 v65, 0xbfb8aa3b, v65
    v_mul_f32 v66, 0xbfb8aa3b, v66
    v_mul_f32 v67, 0xbfb8aa3b, v67
    v_exp_f32 v64, v64
    v_exp_f32 v65, v65
    v_exp_f32 v66, v66
    v_exp_f32 v67, v67
    v_add_f32 v64, 1.0, v64
    v_add_f32 v65, 1.0, v65
    v_add_f32 v66, 1.0, v66
    v_add_f32 v67, 1.0, v67
    v_rcp_f32 v64, v64
    v_rcp_f32 v65, v65
    v_rcp_f32 v66, v66
    v_rcp_f32 v67, v67
    v_mul_f32 v64, v64, v68
    v_mul_f32 v65, v65, v69
    v_mul_f32 v66, v66, v70
    v_mul_f32 v67, v67, v71
    v_cvt_pk_bf16_f32 v72, v64, v65
    v_cvt_pk_bf16_f32 v73, v66, v67
    v_and_b32 v74, v106, v72
    v_and_b32 v75, v106, v73
    v_and_b32 v76, v107, v72
    v_and_b32 v77, v107, v73
    v_and_b32 v78, v108, v72
    v_and_b32 v79, v108, v73
    v_and_b32 v80, v109, v72
    v_and_b32 v81, v109, v73
    v_mfma_f32_16x16x16_bf16 v[160:163], v[48:49], v[74:75], 0
    v_mfma_f32_16x16x16_bf16 v[164:167], v[50:51], v[74:75], 0
    v_mfma_f32_16x16x16_bf16 v[160:163], v[52:53], v[76:77], v[160:163]
    v_mfma_f32_16x16x16_bf16 v[164:167], v[54:55], v[76:77], v[164:167]
    v_mfma_f32_16x16x16_bf16 v[160:163], v[56:57], v[78:79], v[160:163]
    v_mfma_f32_16x16x16_bf16 v[164:167], v[58:59], v[78:79], v[164:167]
    v_mfma_f32_16x16x16_bf16 v[160:163], v[60:61], v[80:81], v[160:163]
    v_mfma_f32_16x16x16_bf16 v[164:167], v[62:63], v[80:81], v[164:167]
    s_nop 6
    v_cvt_pk_bf16_f32 v152, v160, v161
    v_cvt_pk_bf16_f32 v153, v162, v163
    v_cvt_pk_bf16_f32 v154, v164, v165
    v_cvt_pk_bf16_f32 v155, v166, v167
    v_min_u32 v155, -2, v155
    buffer_store_dwordx4 v[152:155], v104, s[4:7], s3 offen sc1
    s_mul_i32 s3, s52, 3
    s_cmp_lg_u32 s3, s66
    s_cbranch_scc1 L_Aend
    s_cmp_ge_u32 s52, 32
    s_cbranch_scc1 L_Aend
    s_mov_b64 s[48:49], s[4:5]
    s_mov_b32 s50, 0x1f0000
    s_mov_b32 s51, 0x20000
    s_mov_b64 s[36:37], s[32:33]
    s_mov_b32 s38, 4096
    v_lshrrev_b32 v10, 3, v1
    v_lshlrev_b32 v10, 12, v10
    v_and_b32 v11, 7, v1
    v_lshl_add_u32 v10, v11, 4, v10
    s_lshl_b32 s3, s60, 15
    s_lshl_b32 s69, s52, 7
    s_add_u32 s3, s3, s69
    s_add_u32 s3, s3, 0x180000
    v_lshlrev_b32 v11, 3, v1
    v_add_u32 v11, 24576, v11
    s_lshl_b32 s69, s60, 9
    v_add_u32 v12, s69, v11
    s_lshl_b32 s69, s52, 6
    s_add_u32 s69, s69, 16384
    v_and_b32 v15, 3, v1
    v_lshlrev_b32 v14, 11, v15
    v_lshl_add_u32 v14, v158, 2, v14
    v_add_u32 v14, s69, v14
    ds_read_b64 v[96:97], v14
    s_waitcnt vmcnt(0)
P_36:
    s_add_u32 s69, s3, 0
    buffer_load_dwordx4 v[64:67], v10, s[48:51], s69 offen sc1
    s_add_u32 s69, s3, 131072
    buffer_load_dwordx4 v[68:71], v10, s[48:51], s69 offen sc1
    s_add_u32 s69, s3, 262144
    buffer_load_dwordx4 v[72:75], v10, s[48:51], s69 offen sc1
    s_add_u32 s69, s3, 393216
    buffer_load_dwordx4 v[76:79], v10, s[48:51], s69 offen sc1
    s_waitcnt vmcnt(3)
    v_dot2_f32_bf16 v144, v64, s67, 0
    v_dot2_f32_bf16 v145, v64, s65, 0
    v_dot2_f32_bf16 v146, v65, s67, 0
    v_dot2_f32_bf16 v147, v65, s65, 0
    v_dot2_f32_bf16 v148, v66, s67, 0
    v_dot2_f32_bf16 v149, v66, s65, 0
    v_dot2_f32_bf16 v150, v67, s67, 0
    v_dot2_f32_bf16 v151, v67, s65, 0
    s_waitcnt vmcnt(2)
    v_dot2c_f32_bf16 v144, s67, v68
    v_dot2c_f32_bf16 v145, s65, v68
    v_dot2c_f32_bf16 v146, s67, v69
    v_dot2c_f32_bf16 v147, s65, v69
    v_dot2c_f32_bf16 v148, s67, v70
    v_dot2c_f32_bf16 v149, s65, v70
    v_dot2c_f32_bf16 v150, s67, v71
    v_dot2c_f32_bf16 v151, s65, v71
    s_waitcnt vmcnt(1)
    v_dot2c_f32_bf16 v144, s67, v72
    v_dot2c_f32_bf16 v145, s65, v72
    v_dot2c_f32_bf16 v146, s67, v73
    v_dot2c_f32_bf16 v147, s65, v73
    v_dot2c_f32_bf16 v148, s67, v74
    v_dot2c_f32_bf16 v149, s65, v74
    v_dot2c_f32_bf16 v150, s67, v75
    v_dot2c_f32_bf16 v151, s65, v75
    s_waitcnt vmcnt(0)
    v_dot2c_f32_bf16 v144, s67, v76
    v_dot2c_f32_bf16 v145, s65, v76
    v_dot2c_f32_bf16 v146, s67, v77
    v_dot2c_f32_bf16 v147, s65, v77
    v_dot2c_f32_bf16 v148, s67, v78
    v_dot2c_f32_bf16 v149, s65, v78
    v_dot2c_f32_bf16 v150, s67, v79
    v_dot2c_f32_bf16 v151, s65, v79
    v_max3_u32 v13, v67, v71, v75
    v_max_u32 v13, v13, v79
    v_cmp_eq_u32 vcc, -1, v13
    s_cbranch_vccz Q_37
    s_add_u32 s64, s64, 1
    s_cmp_gt_u32 s64, 200000
    s_cbranch_scc1 Q_37
    s_sleep 1
    s_branch P_36
Q_37:
    v_permlane32_swap_b32 v144, v148
    v_permlane32_swap_b32 v145, v149
    v_permlane32_swap_b32 v146, v150
    v_permlane32_swap_b32 v147, v151
    v_add_f32 v144, v144, v148
    v_add_f32 v145, v145, v149
    v_add_f32 v146, v146, v150
    v_add_f32 v147, v147, v151
    s_nop 0
    v_permlane16_swap_b32 v144, v146
    v_permlane16_swap_b32 v145, v147
    v_add_f32 v144, v144, v146
    v_add_f32 v145, v145, v147
    s_nop 0
    v_add_f32_dpp v144, v144, v144 row_ror:8 row_mask:0xf bank_mask:0xf
    v_add_f32_dpp v145, v145, v145 row_ror:8 row_mask:0xf bank_mask:0xf
    ds_write_b64 v12, v[144:145]
    s_waitcnt lgkmcnt(0)
    s_barrier
    s_cmp_lg_u32 s60, 0
    s_cbranch_scc1 L_Aend
    ds_read_b64 v[66:67], v11 offset:512
    ds_read_b64 v[68:69], v11 offset:1024
    ds_read_b64 v[70:71], v11 offset:1536
    s_lshl_b32 s3, s52, 5
    v_lshlrev_b32 v10, 10, v15
    v_lshl_add_u32 v10, v158, 1, v10
    s_waitcnt lgkmcnt(0)
    v_pk_add_f32 v[144:145], v[144:145], v[66:67]
    v_pk_add_f32 v[68:69], v[68:69], v[70:71]
    v_pk_add_f32 v[144:145], v[144:145], v[68:69]
    v_pk_fma_f32 v[96:97], v[98:99], v[144:145], v[96:97]
    v_cvt_pk_bf16_f32 v96, v96, v97
    s_mov_b32 exec_lo, 0xff00ff
    s_mov_b32 exec_hi, 0xff00ff
    buffer_store_dword v96, v10, s[36:39], s3 offen
    s_cmp_lg_u32 s66, 0
    s_cbranch_scc1 L_Aend
    s_mov_b64 exec, 1
    v_mov_b32 v96, s63
    v_mov_b32 v97, 0
    buffer_store_dword v96, v97, s[4:7], 0 offen
L_Aend:
    s_endpgm
L_F:
    s_lshr_b32 s66, s62, 2
    s_lshl_b32 s3, s61, 2
    s_add_u32 s66, s66, s3
    s_and_b32 s67, s62, 3
    s_lshl_b32 s68, s61, 4
    s_add_u32 s68, s68, s62
    s_add_u32 s51, s62, 4
    s_and_b32 s51, s51, 15
    v_lshrrev_b32 v10, 4, v1
    v_and_b32 v11, 15, v1
    v_lshlrev_b32 v12, 2, v10
    v_xor_b32 v12, v12, v11
    v_lshlrev_b32 v12, 4, v12
    v_lshl_add_u32 v3, v10, 13, v12
    s_waitcnt lgkmcnt(0)
    s_load_dword s63, s[4:5], 0
    s_cmp_eq_u32 s60, 4
    s_cbranch_scc1 L_FH
    s_cmp_ge_u32 s61, 4
    s_cselect_b64 vcc, -1, 0
    s_mov_b64 s[36:37], s[12:13]
    s_lshl_b32 s3, s67, 2
    s_add_u32 s3, s3, s60
    s_lshl_b32 s3, s3, 18
    s_lshl_b32 s69, s66, 8
    s_add_u32 s3, s3, s69
    s_lshl_b32 s69, s60, 13
    s_add_u32 m0, s69, 0
    s_nop 0
    buffer_load_dwordx4 v3, s[36:39], s3 offen nt lds
    s_add_u32 m0, s69, 1024
    s_add_u32 s3, s3, 32768
    buffer_load_dwordx4 v3, s[36:39], s3 offen nt lds
    s_add_u32 m0, s69, 2048
    s_add_u32 s3, s3, 32768
    buffer_load_dwordx4 v3, s[36:39], s3 offen nt lds
    s_add_u32 m0, s69, 3072
    s_add_u32 s3, s3, 32768
    buffer_load_dwordx4 v3, s[36:39], s3 offen nt lds
    s_add_u32 m0, s69, 4096
    s_add_u32 s3, s3, 32768
    buffer_load_dwordx4 v3, s[36:39], s3 offen nt lds
    s_add_u32 m0, s69, 5120
    s_add_u32 s3, s3, 32768
    buffer_load_dwordx4 v3, s[36:39], s3 offen nt lds
    s_add_u32 m0, s69, 6144
    s_add_u32 s3, s3, 32768
    buffer_load_dwordx4 v3, s[36:39], s3 offen nt lds
    s_cbranch_vccnz W_38
    s_waitcnt vmcnt(6)
W_38:
    s_add_u32 m0, s69, 7168
    s_add_u32 s3, s3, 32768
    buffer_load_dwordx4 v3, s[36:39], s3 offen nt lds
    s_mov_b64 s[36:37], s[14:15]
    s_lshl_b32 s3, s67, 2
    s_add_u32 s3, s3, s60
    s_lshl_b32 s3, s3, 18
    s_lshl_b32 s69, s66, 8
    s_add_u32 s3, s3, s69
    s_lshl_b32 s69, s60, 13
    s_cbranch_vccnz W_39
    s_waitcnt vmcnt(6)
W_39:
    s_add_u32 m0, s69, 32768
    s_nop 0
    buffer_load_dwordx4 v3, s[36:39], s3 offen nt lds
    s_cbranch_vccnz W_40
    s_waitcnt vmcnt(6)
W_40:
    s_waitcnt vmcnt(8)
    s_add_u32 m0, s69, 33792
    s_add_u32 s3, s3, 32768
    buffer_load_dwordx4 v3, s[36:39], s3 offen nt lds
    s_cbranch_vccnz W_41
    s_waitcnt vmcnt(6)
W_41:
    s_waitcnt vmcnt(8)
    s_add_u32 m0, s69, 34816
    s_add_u32 s3, s3, 32768
    buffer_load_dwordx4 v3, s[36:39], s3 offen nt lds
    s_cbranch_vccnz W_42
    s_waitcnt vmcnt(6)
W_42:
    s_waitcnt vmcnt(8)
    s_add_u32 m0, s69, 35840
    s_add_u32 s3, s3, 32768
    buffer_load_dwordx4 v3, s[36:39], s3 offen nt lds
    s_cbranch_vccnz W_43
    s_waitcnt vmcnt(6)
W_43:
    s_waitcnt vmcnt(8)
    s_add_u32 m0, s69, 36864
    s_add_u32 s3, s3, 32768
    buffer_load_dwordx4 v3, s[36:39], s3 offen nt lds
    s_cbranch_vccnz W_44
    s_waitcnt vmcnt(6)
W_44:
    s_waitcnt vmcnt(8)
    s_add_u32 m0, s69, 37888
    s_add_u32 s3, s3, 32768
    buffer_load_dwordx4 v3, s[36:39], s3 offen nt lds
    s_cbranch_vccnz W_45
    s_waitcnt vmcnt(6)
W_45:
    s_waitcnt vmcnt(8)
    s_add_u32 m0, s69, 38912
    s_add_u32 s3, s3, 32768
    buffer_load_dwordx4 v3, s[36:39], s3 offen nt lds
    s_cbranch_vccnz W_46
    s_waitcnt vmcnt(6)
W_46:
    s_waitcnt vmcnt(8)
    s_add_u32 m0, s69, 39936
    s_add_u32 s3, s3, 32768
    buffer_load_dwordx4 v3, s[36:39], s3 offen nt lds
    s_getreg_b32 s65, hwreg(HW_REG_XCC_ID, 0, 4)
    s_waitcnt lgkmcnt(0)
    s_mul_i32 s63, s63, 0x9E3779B1
    s_add_u32 s63, s63, 0x7F4A7C15
    v_bfe_u32 v12, v1, 2, 2
    v_and_b32 v13, 3, v1
    v_lshlrev_b32 v6, 4, v13
    v_lshl_add_u32 v6, v10, 6, v6
    v_lshl_add_u32 v4, v12, 9, v6
    v_lshl_add_u32 v8, v10, 3, v12
    v_lshlrev_b32 v8, 8, v8
    v_xor_b32 v14, s60, v12
    v_lshl_add_u32 v8, v14, 6, v8
    v_lshl_add_u32 v8, v13, 4, v8
    v_lshl_add_u32 v9, v12, 3, v13
    s_lshl_b32 s3, s60, 13
    s_add_u32 s3, s3, 32768
    v_lshlrev_b32 v9, 8, v9
    v_add_u32 v9, s3, v9
    v_lshl_add_u32 v9, v13, 6, v9
    v_lshl_add_u32 v9, v10, 4, v9
    s_lshl_b32 s3, s67, 13
    s_add_u32 s3, s3, 0x2000
    s_add_u32 s69, s3, 4096
    s_lshl_b32 s59, s61, 11
    s_add_u32 s59, s59, 0x10000
    v_lshlrev_b32 v12, 7, v11
    s_waitcnt vmcnt(8)
    s_barrier
    buffer_load_dwordx2 v[14:15], v12, s[4:7], s59 offen sc1
    ds_read_b64_tr_b16 v[16:17], v8 offset:0
    ds_read_b64_tr_b16 v[18:19], v8 offset:1024
    ds_read_b64_tr_b16 v[20:21], v8 offset:8192
    ds_read_b64_tr_b16 v[22:23], v8 offset:9216
    ds_read_b64_tr_b16 v[24:25], v8 offset:16384
    ds_read_b64_tr_b16 v[26:27], v8 offset:17408
    ds_read_b64_tr_b16 v[28:29], v8 offset:24576
    ds_read_b64_tr_b16 v[30:31], v8 offset:25600
    ds_read_b64_tr_b16 v[32:33], v8 offset:8
    ds_read_b64_tr_b16 v[34:35], v8 offset:1032
    ds_read_b64_tr_b16 v[36:37], v8 offset:8200
    ds_read_b64_tr_b16 v[38:39], v8 offset:9224
    ds_read_b64_tr_b16 v[40:41], v8 offset:16392
    ds_read_b64_tr_b16 v[42:43], v8 offset:17416
    ds_read_b64_tr_b16 v[44:45], v8 offset:24584
    ds_read_b64_tr_b16 v[46:47], v8 offset:25608
    s_lshl_b32 s58, s60, 10
    s_add_u32 s58, s58, 147456
    v_add_u32 v126, s58, v2
    v_add_u32 v10, 147456, v2
    s_waitcnt vmcnt(4)
    s_lshl_b32 s69, s60, 11
    s_add_u32 s3, s3, s69
P_47:
    buffer_load_dwordx4 v[80:83], v4, s[4:7], s3 offen sc1
    buffer_load_dwordx4 v[84:87], v4, s[4:7], s3 offen offset:256 sc1
    s_waitcnt vmcnt(0)
    v_xor_b32 v13, s63, v81
    v_bitop3_b32 v13, v13, v86, s63 bitop3:0xf6
    v_cmp_ne_u32 vcc, 0, v13
    s_cbranch_vccz Q_48
    s_add_u32 s64, s64, 1
    s_cmp_gt_u32 s64, 200000
    s_cbranch_scc1 Q_48
    s_sleep 2
    s_branch P_47
Q_48:
    ds_write_b128 v126, v[82:85]
    s_waitcnt lgkmcnt(0)
    s_barrier
    ds_read_b128 v[80:83], v10 offset:0
    ds_read_b128 v[84:87], v10 offset:1024
    ds_read_b128 v[88:91], v10 offset:2048
    ds_read_b128 v[92:95], v10 offset:3072
    ds_read_b128 v[48:51], v9 offset:0
    ds_read_b128 v[64:67], v9 offset:1024
    v_xor_b32 v11, 64, v9
    ds_read_b128 v[52:55], v11 offset:0
    ds_read_b128 v[68:71], v11 offset:1024
    v_xor_b32 v11, 128, v9
    ds_read_b128 v[56:59], v11 offset:0
    ds_read_b128 v[72:75], v11 offset:1024
    v_xor_b32 v11, 192, v9
    ds_read_b128 v[60:63], v11 offset:0
    ds_read_b128 v[76:79], v11 offset:1024
    s_waitcnt lgkmcnt(8)
    v_mfma_f32_16x16x32_bf16 v[112:115], v[16:19], v[80:83], 0
    v_mfma_f32_16x16x32_bf16 v[116:119], v[32:35], v[80:83], 0
    v_mfma_f32_16x16x32_bf16 v[112:115], v[20:23], v[84:87], v[112:115]
    v_mfma_f32_16x16x32_bf16 v[116:119], v[36:39], v[84:87], v[116:119]
    v_mfma_f32_16x16x32_bf16 v[112:115], v[24:27], v[88:91], v[112:115]
    v_mfma_f32_16x16x32_bf16 v[116:119], v[40:43], v[88:91], v[116:119]
    v_mfma_f32_16x16x32_bf16 v[112:115], v[28:31], v[92:95], v[112:115]
    v_mfma_f32_16x16x32_bf16 v[116:119], v[44:47], v[92:95], v[116:119]
    v_xor_b32 v14, s63, v14
    s_mov_b32 s50, s65
    v_bitop3_b32 v15, v14, v15, s65 bitop3:0xf6
    v_mov_b32 v127, v12
    s_mov_b32 s49, s59
    v_cmp_ne_u32 vcc, 0, v15
    s_lshl_b32 s69, s66, 13
    s_lshl_b32 s3, s60, 11
    s_add_u32 s69, s69, s3
    s_add_u32 s69, s69, 0x40000
    s_lshl_b32 s3, s67, 9
    s_add_u32 s3, s3, s69
    s_cmp_eq_u64 vcc, 0
    s_cselect_b32 s65, 1, 0
    v_bfe_u32 v14, v1, 2, 1
    v_cmp_eq_u32 vcc, 0, v14
    v_lshl_add_u32 v14, v14, 8, v6
    v_mov_b32 v15, s63
    v_add_f32_dpp v112, v112, v112 row_ror:4 row_mask:0xf bank_mask:0xf
    v_add_f32_dpp v113, v113, v113 row_ror:4 row_mask:0xf bank_mask:0xf
    v_add_f32_dpp v114, v114, v114 row_ror:4 row_mask:0xf bank_mask:0xf
    v_add_f32_dpp v115, v115, v115 row_ror:4 row_mask:0xf bank_mask:0xf
    v_add_f32_dpp v116, v116, v116 row_ror:4 row_mask:0xf bank_mask:0xf
    v_add_f32_dpp v117, v117, v117 row_ror:4 row_mask:0xf bank_mask:0xf
    v_add_f32_dpp v118, v118, v118 row_ror:4 row_mask:0xf bank_mask:0xf
    v_add_f32_dpp v119, v119, v119 row_ror:4 row_mask:0xf bank_mask:0xf
    v_add_f32_dpp v112, v112, v112 row_ror:8 row_mask:0xf bank_mask:0xf
    v_add_f32_dpp v113, v113, v113 row_ror:8 row_mask:0xf bank_mask:0xf
    v_add_f32_dpp v114, v114, v114 row_ror:8 row_mask:0xf bank_mask:0xf
    v_add_f32_dpp v115, v115, v115 row_ror:8 row_mask:0xf bank_mask:0xf
    v_add_f32_dpp v116, v116, v116 row_ror:8 row_mask:0xf bank_mask:0xf
    v_add_f32_dpp v117, v117, v117 row_ror:8 row_mask:0xf bank_mask:0xf
    v_add_f32_dpp v118, v118, v118 row_ror:8 row_mask:0xf bank_mask:0xf
    v_add_f32_dpp v119, v119, v119 row_ror:8 row_mask:0xf bank_mask:0xf
    v_cvt_pk_bf16_f32 v80, v112, v113
    v_cvt_pk_bf16_f32 v81, v114, v115
    v_cvt_pk_bf16_f32 v82, v116, v117
    v_cvt_pk_bf16_f32 v83, v118, v119
    v_mov_b32 v120, v82
    v_cndmask_b32 v121, v83, v15, vcc
    v_cndmask_b32 v122, v15, v80, vcc
    v_mov_b32 v123, v81
    s_mov_b32 exec_lo, 0xff00ff
    s_mov_b32 exec_hi, 0xff00ff
    s_cmp_eq_u32 s65, 0
    s_cbranch_scc1 G_49
    buffer_store_dwordx4 v[120:123], v14, s[4:7], s3 offen
    s_branch G_50
G_49:
    buffer_store_dwordx4 v[120:123], v14, s[4:7], s3 offen sc1
G_50:
    s_mov_b64 exec, -1
P_51:
    buffer_load_dwordx4 v[80:83], v4, s[4:7], s69 offen sc1
    buffer_load_dwordx4 v[84:87], v4, s[4:7], s69 offen offset:256 sc1
    s_waitcnt vmcnt(0)
    v_xor_b32 v13, s63, v81
    v_bitop3_b32 v13, v13, v86, s63 bitop3:0xf6
    v_cmp_ne_u32 vcc, 0, v13
    s_cbranch_vccz Q_52
    s_add_u32 s64, s64, 1
    s_cmp_gt_u32 s64, 200000
    s_cbranch_scc1 Q_52
    s_branch P_51
Q_52:
    ds_write_b128 v126, v[82:85] offset:4096
    s_waitcnt lgkmcnt(0)
    s_barrier
    ds_read_b128 v[80:83], v10 offset:4096
    ds_read_b128 v[84:87], v10 offset:5120
    ds_read_b128 v[88:91], v10 offset:6144
    ds_read_b128 v[92:95], v10 offset:7168
    s_waitcnt lgkmcnt(0)
    v_mfma_f32_16x16x32_bf16 v[112:115], v[48:51], v[80:83], 0
    v_mfma_f32_16x16x32_bf16 v[116:119], v[64:67], v[80:83], 0
    v_mfma_f32_16x16x32_bf16 v[112:115], v[52:55], v[84:87], v[112:115]
    v_mfma_f32_16x16x32_bf16 v[116:119], v[68:71], v[84:87], v[116:119]
    v_mfma_f32_16x16x32_bf16 v[112:115], v[56:59], v[88:91], v[112:115]
    v_mfma_f32_16x16x32_bf16 v[116:119], v[72:75], v[88:91], v[116:119]
    v_mfma_f32_16x16x32_bf16 v[112:115], v[60:63], v[92:95], v[112:115]
    v_mfma_f32_16x16x32_bf16 v[116:119], v[76:79], v[92:95], v[116:119]
    s_lshl_b32 s3, s68, 8
    s_add_u32 s3, s3, 0x100000
    s_mov_b32 s59, 0x3e0293ee
    s_nop 3
    v_add_f32_dpp v112, v112, v112 row_ror:4 row_mask:0xf bank_mask:0xf
    v_add_f32_dpp v113, v113, v113 row_ror:4 row_mask:0xf bank_mask:0xf
    v_add_f32_dpp v114, v114, v114 row_ror:4 row_mask:0xf bank_mask:0xf
    v_add_f32_dpp v115, v115, v115 row_ror:4 row_mask:0xf bank_mask:0xf
    v_add_f32_dpp v116, v116, v116 row_ror:4 row_mask:0xf bank_mask:0xf
    v_add_f32_dpp v117, v117, v117 row_ror:4 row_mask:0xf bank_mask:0xf
    v_add_f32_dpp v118, v118, v118 row_ror:4 row_mask:0xf bank_mask:0xf
    v_add_f32_dpp v119, v119, v119 row_ror:4 row_mask:0xf bank_mask:0xf
    v_add_f32_dpp v112, v112, v112 row_ror:8 row_mask:0xf bank_mask:0xf
    v_add_f32_dpp v113, v113, v113 row_ror:8 row_mask:0xf bank_mask:0xf
    v_add_f32_dpp v114, v114, v114 row_ror:8 row_mask:0xf bank_mask:0xf
    v_add_f32_dpp v115, v115, v115 row_ror:8 row_mask:0xf bank_mask:0xf
    v_add_f32_dpp v116, v116, v116 row_ror:8 row_mask:0xf bank_mask:0xf
    v_add_f32_dpp v117, v117, v117 row_ror:8 row_mask:0xf bank_mask:0xf
    v_add_f32_dpp v118, v118, v118 row_ror:8 row_mask:0xf bank_mask:0xf
    v_add_f32_dpp v119, v119, v119 row_ror:8 row_mask:0xf bank_mask:0xf
    v_mul_f32 v112, s59, v112
    v_mul_f32 v113, s59, v113
    v_mul_f32 v114, s59, v114
    v_mul_f32 v115, s59, v115
    v_mul_f32 v116, s59, v116
    v_mul_f32 v117, s59, v117
    v_mul_f32 v118, s59, v118
    v_mul_f32 v119, s59, v119
    v_cvt_pk_bf16_f32 v120, v112, v113
    v_cvt_pk_bf16_f32 v121, v114, v115
    v_cvt_pk_bf16_f32 v122, v116, v117
    v_cvt_pk_bf16_f32 v123, v118, v119
    s_lshl_b32 s59, s60, 6
    s_add_u32 s59, s59, 156672
    v_and_b32 v14, 3, v1
    v_lshrrev_b32 v15, 4, v1
    v_lshlrev_b32 v15, 4, v15
    v_lshl_add_u32 v14, v14, 8, v15
    v_add_u32 v14, s59, v14
    s_mov_b32 exec_lo, 0xf000f
    s_mov_b32 exec_hi, 0xf000f
    ds_write_b128 v14, v[120:123]
    s_mov_b64 exec, -1
    v_add_u32 v14, 156672, v2
    v_lshrrev_b32 v13, 4, v1
    v_lshlrev_b32 v15, 15, v13
    v_and_b32 v12, 15, v1
    v_lshl_add_u32 v15, v12, 4, v15
    v_lshlrev_b32 v13, 3, v13
    s_lshl_b32 s59, s68, 7
    s_add_u32 s59, s59, 0x14000
    v_mov_b32 v80, s63
    s_waitcnt lgkmcnt(0)
    s_barrier
    s_cmp_lg_u32 s60, 0
    s_cbranch_scc1 F_53
    ds_read_b128 v[120:123], v14
    s_waitcnt lgkmcnt(0)
    buffer_store_dwordx4 v[120:123], v15, s[4:7], s3 offen sc1
    v_add3_u32 v81, v120, v121, v122
    v_add_u32 v81, v81, v123
    s_nop 1
    v_add_u32_dpp v81, v81, v81 row_ror:1 row_mask:0xf bank_mask:0xf
    s_nop 1
    v_add_u32_dpp v81, v81, v81 row_ror:2 row_mask:0xf bank_mask:0xf
    s_nop 1
    v_add_u32_dpp v81, v81, v81 row_ror:4 row_mask:0xf bank_mask:0xf
    s_nop 1
    v_add_u32_dpp v81, v81, v81 row_ror:8 row_mask:0xf bank_mask:0xf
    s_nop 0
    v_readlane_b32 s52, v81, 0
    v_readlane_b32 s53, v81, 16
    v_readlane_b32 s54, v81, 32
    v_readlane_b32 s55, v81, 48
    v_mov_b32 v81, s52
    v_mov_b32 v83, s53
    v_mov_b32 v82, s63
    v_writelane_b32 v81, s54, 1
    v_writelane_b32 v83, s55, 1
    s_mov_b64 exec, 3
    buffer_store_dwordx4 v[80:83], v2, s[4:7], s59 offen sc1
    s_mov_b64 exec, -1
    s_waitcnt vmcnt(0)
F_53:
    s_barrier
    v_and_b32 v13, 3, v1
    v_lshrrev_b32 v10, 4, v1
    v_and_b32 v12, 15, v1
    v_lshlrev_b32 v12, 4, v12
    v_lshl_add_u32 v12, v10, 10, v12
    s_lshl_b32 s3, s67, 8
    buffer_load_dwordx2 v[176:177], v127, s[4:7], s49 offen sc1
    s_mov_b64 s[40:41], s[28:29]
    buffer_load_dwordx4 v[80:83], v12, s[40:43], s3 offen
    s_mov_b64 s[36:37], s[16:17]
    s_lshl_b32 s3, s67, 2
    s_add_u32 s3, s3, s60
    s_lshl_b32 s3, s3, 18
    s_lshl_b32 s69, s66, 8
    s_add_u32 s3, s3, s69
    s_lshl_b32 s69, s60, 13
    s_add_u32 m0, s69, 65536
    s_nop 0
    buffer_load_dwordx4 v3, s[36:39], s3 offen nt lds
    s_add_u32 m0, s69, 66560
    s_add_u32 s3, s3, 32768
    buffer_load_dwordx4 v3, s[36:39], s3 offen nt lds
    s_add_u32 m0, s69, 67584
    s_add_u32 s3, s3, 32768
    buffer_load_dwordx4 v3, s[36:39], s3 offen nt lds
    s_add_u32 m0, s69, 68608
    s_add_u32 s3, s3, 32768
    buffer_load_dwordx4 v3, s[36:39], s3 offen nt lds
    s_add_u32 m0, s69, 69632
    s_add_u32 s3, s3, 32768
    buffer_load_dwordx4 v3, s[36:39], s3 offen nt lds
    s_add_u32 m0, s69, 70656
    s_add_u32 s3, s3, 32768
    buffer_load_dwordx4 v3, s[36:39], s3 offen nt lds
    s_add_u32 m0, s69, 71680
    s_add_u32 s3, s3, 32768
    buffer_load_dwordx4 v3, s[36:39], s3 offen nt lds
    s_add_u32 m0, s69, 72704
    s_add_u32 s3, s3, 32768
    buffer_load_dwordx4 v3, s[36:39], s3 offen nt lds
    s_mov_b64 s[40:41], s[30:31]
    v_lshrrev_b32 v10, 3, v1
    v_mul_u32_u24 v10, 6144, v10
    v_and_b32 v11, 7, v1
    v_lshl_add_u32 v10, v11, 4, v10
    s_lshl_b32 s3, s67, 2
    s_add_u32 s3, s3, s60
    s_mul_i32 s3, s3, 196608
    s_lshl_b32 s69, s66, 7
    s_add_u32 s3, s3, s69
    s_add_u32 s3, s3, 2048
    s_lshl_b32 s69, s60, 12
    s_add_u32 s69, s69, 131072
    s_waitcnt vmcnt(11)
    s_add_u32 m0, s69, 0
    s_nop 0
    buffer_load_dwordx4 v10, s[40:43], s3 offen nt lds
    s_add_u32 s3, s3, 49152
    s_waitcnt vmcnt(11)
    s_add_u32 m0, s69, 1024
    s_nop 0
    buffer_load_dwordx4 v10, s[40:43], s3 offen nt lds
    s_add_u32 s3, s3, 49152
    s_waitcnt vmcnt(11)
    s_add_u32 m0, s69, 2048
    s_nop 0
    buffer_load_dwordx4 v10, s[40:43], s3 offen nt lds
    s_add_u32 s3, s3, 49152
    s_waitcnt vmcnt(11)
    s_add_u32 m0, s69, 3072
    s_nop 0
    buffer_load_dwordx4 v10, s[40:43], s3 offen nt lds
    s_mov_b64 s[36:37], s[18:19]
    v_lshrrev_b32 v155, 3, v1
    v_lshlrev_b32 v155, 10, v155
    v_and_b32 v156, 7, v1
    v_lshl_add_u32 v155, v156, 4, v155
    s_lshl_b32 s58, s61, 1
    s_and_b32 s57, s51, 1
    s_add_u32 s58, s58, s57
    s_lshl_b32 s58, s58, 2
    s_add_u32 s58, s58, s60
    s_lshl_b32 s58, s58, 16
    s_lshr_b32 s57, s51, 1
    s_lshl_b32 s57, s57, 7
    s_add_u32 s58, s58, s57
    s_lshl_b32 s57, s60, 13
    s_waitcnt vmcnt(11)
    s_add_u32 m0, s57, 98304
    s_nop 0
    buffer_load_dwordx4 v155, s[36:39], s58 offen nt lds
    s_waitcnt vmcnt(11)
    s_add_u32 m0, s57, 99328
    s_add_u32 s58, s58, 8192
    buffer_load_dwordx4 v155, s[36:39], s58 offen nt lds
    s_waitcnt vmcnt(11)
    s_add_u32 m0, s57, 100352
    s_add_u32 s58, s58, 8192
    buffer_load_dwordx4 v155, s[36:39], s58 offen nt lds
    s_waitcnt vmcnt(11)
    s_add_u32 m0, s57, 101376
    s_add_u32 s58, s58, 8192
    buffer_load_dwordx4 v155, s[36:39], s58 offen nt lds
    s_waitcnt vmcnt(11)
    s_add_u32 m0, s57, 102400
    s_add_u32 s58, s58, 8192
    buffer_load_dwordx4 v155, s[36:39], s58 offen nt lds
    s_waitcnt vmcnt(11)
    s_add_u32 m0, s57, 103424
    s_add_u32 s58, s58, 8192
    buffer_load_dwordx4 v155, s[36:39], s58 offen nt lds
    s_waitcnt vmcnt(11)
    s_add_u32 m0, s57, 104448
    s_add_u32 s58, s58, 8192
    buffer_load_dwordx4 v155, s[36:39], s58 offen nt lds
    s_waitcnt vmcnt(11)
    s_add_u32 m0, s57, 105472
    s_add_u32 s58, s58, 8192
    buffer_load_dwordx4 v155, s[36:39], s58 offen nt lds
    s_waitcnt vmcnt(20)
    v_cmp_ne_u32 vcc, s63, v176
    s_cbranch_vccz K_54
P_55:
    buffer_load_dwordx2 v[176:177], v127, s[4:7], s49 offen sc1
    s_waitcnt vmcnt(0)
    v_cmp_ne_u32 vcc, s63, v176
    s_cbranch_vccz Q_56
    s_add_u32 s64, s64, 1
    s_cmp_gt_u32 s64, 200000
    s_cbranch_scc1 Q_56
    s_sleep 4
    s_branch P_55
Q_56:
K_54:
    v_cmp_ne_u32 vcc, s50, v177
    s_nop 0
    s_cmp_eq_u64 vcc, 0
    s_cselect_b32 s65, 1, 0
    v_lshlrev_b32 v176, 16, v80
    v_and_b32 v177, 0xffff0000, v80
    v_lshlrev_b32 v178, 16, v81
    v_and_b32 v179, 0xffff0000, v81
    v_lshlrev_b32 v180, 16, v82
    v_and_b32 v181, 0xffff0000, v82
    v_lshlrev_b32 v182, 16, v83
    v_and_b32 v183, 0xffff0000, v83
    v_mul_f32 v184, 0xbfb8aa3b, v176
    v_mul_f32 v185, 0xbfb8aa3b, v177
    v_mul_f32 v186, 0xbfb8aa3b, v178
    v_mul_f32 v187, 0xbfb8aa3b, v179
    v_mul_f32 v188, 0xbfb8aa3b, v180
    v_mul_f32 v189, 0xbfb8aa3b, v181
    v_mul_f32 v190, 0xbfb8aa3b, v182
    v_mul_f32 v191, 0xbfb8aa3b, v183
    v_exp_f32 v184, v184
    v_exp_f32 v185, v185
    v_exp_f32 v186, v186
    v_exp_f32 v187, v187
    v_exp_f32 v188, v188
    v_exp_f32 v189, v189
    v_exp_f32 v190, v190
    v_exp_f32 v191, v191
    v_add_f32 v184, 1.0, v184
    v_add_f32 v185, 1.0, v185
    v_add_f32 v186, 1.0, v186
    v_add_f32 v187, 1.0, v187
    v_add_f32 v188, 1.0, v188
    v_add_f32 v189, 1.0, v189
    v_add_f32 v190, 1.0, v190
    v_add_f32 v191, 1.0, v191
    v_rcp_f32 v184, v184
    v_rcp_f32 v185, v185
    v_rcp_f32 v186, v186
    v_rcp_f32 v187, v187
    v_rcp_f32 v188, v188
    v_rcp_f32 v189, v189
    v_rcp_f32 v190, v190
    v_rcp_f32 v191, v191
    v_mul_f32 v176, v176, v184
    v_mul_f32 v177, v177, v185
    v_mul_f32 v178, v178, v186
    v_mul_f32 v179, v179, v187
    v_mul_f32 v180, v180, v188
    v_mul_f32 v181, v181, v189
    v_mul_f32 v182, v182, v190
    v_mul_f32 v183, v183, v191
    v_cvt_pk_bf16_f32 v160, v176, v177
    v_cvt_pk_bf16_f32 v161, v178, v179
    v_cvt_pk_bf16_f32 v162, v180, v181
    v_cvt_pk_bf16_f32 v163, v182, v183
    ds_write_b128 v126, v[160:163]
    v_lshrrev_b32 v14, 4, v1
    v_lshlrev_b32 v14, 4, v14
    v_lshl_add_u32 v14, v13, 8, v14
    s_lshl_b32 s3, s60, 10
    s_add_u32 s3, s3, 147456
    v_add_u32 v14, s3, v14
    s_waitcnt lgkmcnt(0)
    ds_read_b128 v[160:163], v14 offset:0
    ds_read_b128 v[164:167], v14 offset:64
    ds_read_b128 v[168:171], v14 offset:128
    ds_read_b128 v[172:175], v14 offset:192
    s_waitcnt vmcnt(8)
    s_barrier
    v_add_u32 v10, 65536, v8
    ds_read_b64_tr_b16 v[16:17], v10 offset:0
    ds_read_b64_tr_b16 v[18:19], v10 offset:1024
    ds_read_b64_tr_b16 v[20:21], v10 offset:8192
    ds_read_b64_tr_b16 v[22:23], v10 offset:9216
    ds_read_b64_tr_b16 v[24:25], v10 offset:16384
    ds_read_b64_tr_b16 v[26:27], v10 offset:17408
    ds_read_b64_tr_b16 v[28:29], v10 offset:24576
    ds_read_b64_tr_b16 v[30:31], v10 offset:25600
    ds_read_b64_tr_b16 v[32:33], v10 offset:8
    ds_read_b64_tr_b16 v[34:35], v10 offset:1032
    ds_read_b64_tr_b16 v[36:37], v10 offset:8200
    ds_read_b64_tr_b16 v[38:39], v10 offset:9224
    ds_read_b64_tr_b16 v[40:41], v10 offset:16392
    ds_read_b64_tr_b16 v[42:43], v10 offset:17416
    ds_read_b64_tr_b16 v[44:45], v10 offset:24584
    ds_read_b64_tr_b16 v[46:47], v10 offset:25608
    s_cmp_gt_u32 s60, 1
    s_cbranch_scc1 F_57
    v_lshrrev_b32 v10, 4, v1
    v_bfe_u32 v12, v1, 2, 2
    v_lshl_add_u32 v10, v10, 3, v12
    v_lshlrev_b32 v10, 7, v10
    v_lshl_add_u32 v10, v13, 4, v10
    s_lshl_b32 s3, s60, 6
    s_add_u32 s3, s3, 131072
    v_add_u32 v10, s3, v10
    ds_read_b64_tr_b16 v[128:129], v10 offset:0
    ds_read_b64_tr_b16 v[130:131], v10 offset:512
    ds_read_b64_tr_b16 v[132:133], v10 offset:4096
    ds_read_b64_tr_b16 v[134:135], v10 offset:4608
    ds_read_b64_tr_b16 v[136:137], v10 offset:8192
    ds_read_b64_tr_b16 v[138:139], v10 offset:8704
    ds_read_b64_tr_b16 v[140:141], v10 offset:12288
    ds_read_b64_tr_b16 v[142:143], v10 offset:12800
    ds_read_b64_tr_b16 v[144:145], v10 offset:8
    ds_read_b64_tr_b16 v[146:147], v10 offset:520
    ds_read_b64_tr_b16 v[148:149], v10 offset:4104
    ds_read_b64_tr_b16 v[150:151], v10 offset:4616
    ds_read_b64_tr_b16 v[152:153], v10 offset:8200
    ds_read_b64_tr_b16 v[154:155], v10 offset:8712
    ds_read_b64_tr_b16 v[156:157], v10 offset:12296
    ds_read_b64_tr_b16 v[158:159], v10 offset:12808
    s_waitcnt lgkmcnt(0)
    v_mfma_f32_16x16x32_bf16 v[112:115], v[128:131], v[160:163], 0
    v_mfma_f32_16x16x32_bf16 v[116:119], v[144:147], v[160:163], 0
    v_mfma_f32_16x16x32_bf16 v[112:115], v[132:135], v[164:167], v[112:115]
    v_mfma_f32_16x16x32_bf16 v[116:119], v[148:151], v[164:167], v[116:119]
    v_mfma_f32_16x16x32_bf16 v[112:115], v[136:139], v[168:171], v[112:115]
    v_mfma_f32_16x16x32_bf16 v[116:119], v[152:155], v[168:171], v[116:119]
    v_mfma_f32_16x16x32_bf16 v[112:115], v[140:143], v[172:175], v[112:115]
    v_mfma_f32_16x16x32_bf16 v[116:119], v[156:159], v[172:175], v[116:119]
    s_lshl_b32 s3, s67, 14
    s_lshl_b32 s69, s66, 7
    s_add_u32 s3, s3, s69
    s_lshl_b32 s69, s60, 6
    s_add_u32 s3, s3, s69
    s_add_u32 s3, s3, 0x140000
    v_lshrrev_b32 v10, 4, v1
    v_lshlrev_b32 v10, 4, v10
    v_lshl_add_u32 v10, v13, 12, v10
    v_cvt_pk_bf16_f32 v120, v112, v113
    v_cvt_pk_bf16_f32 v121, v114, v115
    v_cvt_pk_bf16_f32 v122, v116, v117
    v_cvt_pk_bf16_f32 v123, v118, v119
    v_min_u32 v123, -2, v123
    s_mov_b32 exec_lo, 0xf000f
    s_mov_b32 exec_hi, 0xf000f
    buffer_store_dwordx4 v[120:123], v10, s[4:7], s3 offen sc1
    s_mov_b64 exec, -1
F_57:
    s_waitcnt vmcnt(0)
    s_lshl_b32 s3, s68, 15
    s_lshl_b32 s69, s60, 13
    s_add_u32 s3, s3, s69
    s_add_u32 s3, s3, 0x400000
    s_add_u32 s69, s3, 4096
    s_lshl_b32 s59, s60, 12
    s_lshl_b32 vcc_lo, s67, 7
    s_add_u32 s59, s59, vcc_lo
    s_lshl_b32 vcc_lo, s66, 2
    s_add_u32 s59, s59, vcc_lo
    s_add_u32 s59, s59, 0x130000
    v_lshrrev_b32 v10, 4, v1
    v_and_b32 v11, 7, v1
    v_lshl_add_u32 v11, v10, 5, v11
    v_lshlrev_b32 v11, 9, v11
    v_mov_b32 v152, 0
    s_mul_i32 s56, s63, -8
    s_lshl_b32 vcc_lo, s60, 5
    s_add_u32 vcc_lo, vcc_lo, 155648
    v_lshlrev_b32 v12, 7, v10
    v_add_u32 v12, vcc_lo, v12
    v_lshlrev_b32 v13, 2, v10
    v_add_u32 v13, 156160, v13
    s_cmp_lg_u32 s60, 0
    s_cbranch_scc1 F_58
    v_lshlrev_b32 v160, 9, v1
    s_lshl_b32 s52, s66, 4
    s_add_u32 s52, s52, 0x120000
    s_add_u32 s53, s52, 32768
P_59:
    buffer_load_dwordx3 v[172:174], v160, s[4:7], s52 offen sc1
    buffer_load_dwordx3 v[176:178], v160, s[4:7], s53 offen sc1
    s_waitcnt vmcnt(0)
    v_xor_b32 v161, s63, v174
    v_bitop3_b32 v161, v161, v178, s63 bitop3:0xf6
    v_cmp_ne_u32 vcc, 0, v161
    s_cbranch_vccz Q_60
    s_add_u32 s64, s64, 1
    s_cmp_gt_u32 s64, 200000
    s_cbranch_scc1 Q_60
    s_sleep 1
    s_branch P_59
Q_60:
    v_mov_b32 v164, v172
    v_mov_b32 v165, v173
    v_mov_b32 v166, v176
    v_mov_b32 v167, v177
    v_mov_b32 v168, v164
    v_mov_b32 v169, v166
    s_nop 0
    v_max_f32_dpp v168, v168, v168 row_ror:1 row_mask:0xf bank_mask:0xf
    v_max_f32_dpp v169, v169, v169 row_ror:1 row_mask:0xf bank_mask:0xf
    s_nop 0
    v_max_f32_dpp v168, v168, v168 row_ror:2 row_mask:0xf bank_mask:0xf
    v_max_f32_dpp v169, v169, v169 row_ror:2 row_mask:0xf bank_mask:0xf
    s_nop 0
    v_max_f32_dpp v168, v168, v168 row_ror:4 row_mask:0xf bank_mask:0xf
    v_max_f32_dpp v169, v169, v169 row_ror:4 row_mask:0xf bank_mask:0xf
    s_nop 0
    v_max_f32_dpp v168, v168, v168 row_ror:8 row_mask:0xf bank_mask:0xf
    v_max_f32_dpp v169, v169, v169 row_ror:8 row_mask:0xf bank_mask:0xf
    v_mov_b32 v170, v168
    v_mov_b32 v171, v169
    s_nop 0
    v_permlane16_swap_b32 v168, v170
    v_permlane16_swap_b32 v169, v171
    v_max_f32 v168, v168, v170
    v_max_f32 v169, v169, v171
    v_sub_f32 v164, v164, v168
    v_sub_f32 v166, v166, v169
    v_exp_f32 v164, v164
    v_exp_f32 v166, v166
    v_cvt_pk_bf16_f32 v164, v164, 0
    v_cvt_pk_bf16_f32 v166, v166, 0
    v_lshlrev_b32 v161, 2, v1
    v_add_u32 v161, 155648, v161
    ds_write_b32 v161, v164
    ds_write_b32 v161, v166 offset:256
    v_lshlrev_b32 v168, 16, v164
    v_lshlrev_b32 v169, 16, v166
    v_mul_f32 v168, v168, v165
    v_mul_f32 v169, v169, v167
    s_nop 0
    v_add_f32_dpp v168, v168, v168 row_ror:1 row_mask:0xf bank_mask:0xf
    v_add_f32_dpp v169, v169, v169 row_ror:1 row_mask:0xf bank_mask:0xf
    s_nop 0
    v_add_f32_dpp v168, v168, v168 row_ror:2 row_mask:0xf bank_mask:0xf
    v_add_f32_dpp v169, v169, v169 row_ror:2 row_mask:0xf bank_mask:0xf
    s_nop 0
    v_add_f32_dpp v168, v168, v168 row_ror:4 row_mask:0xf bank_mask:0xf
    v_add_f32_dpp v169, v169, v169 row_ror:4 row_mask:0xf bank_mask:0xf
    s_nop 0
    v_add_f32_dpp v168, v168, v168 row_ror:8 row_mask:0xf bank_mask:0xf
    v_add_f32_dpp v169, v169, v169 row_ror:8 row_mask:0xf bank_mask:0xf
    v_mov_b32 v170, v168
    v_mov_b32 v171, v169
    s_nop 0
    v_permlane16_swap_b32 v168, v170
    v_permlane16_swap_b32 v169, v171
    v_add_f32 v168, v168, v170
    v_add_f32 v169, v169, v171
    v_rcp_f32 v168, v168
    v_rcp_f32 v169, v169
    v_lshrrev_b32 v161, 5, v1
    v_lshlrev_b32 v161, 2, v161
    v_add_u32 v161, 156160, v161
    ds_write_b32 v161, v168
    ds_write_b32 v161, v169 offset:8
F_58:
    s_waitcnt lgkmcnt(0)
    s_barrier
    s_mul_i32 vcc_lo, s60, 1088
    s_add_u32 vcc_lo, vcc_lo, 147456
    v_mul_u32_u24 v14, 272, v10
    v_and_b32 v15, 15, v1
    v_lshl_add_u32 v14, v15, 4, v14
    v_add_u32 v14, vcc_lo, v14
    v_mul_u32_u24 v15, 272, v15
    v_lshl_add_u32 v15, v10, 4, v15
    v_add_u32 v15, 147456, v15
    buffer_load_dwordx4 v[80:83], v2, s[4:7], s3 offen offset:0 sc1
    buffer_load_dwordx4 v[84:87], v2, s[4:7], s3 offen offset:1024 sc1
    buffer_load_dwordx4 v[88:91], v2, s[4:7], s3 offen offset:2048 sc1
    buffer_load_dwordx4 v[92:95], v2, s[4:7], s3 offen offset:3072 sc1
    buffer_load_dwordx4 v[96:99], v2, s[4:7], s69 offen offset:0 sc1
    buffer_load_dwordx4 v[100:103], v2, s[4:7], s69 offen offset:1024 sc1
    buffer_load_dwordx4 v[104:107], v2, s[4:7], s69 offen offset:2048 sc1
    buffer_load_dwordx4 v[108:111], v2, s[4:7], s69 offen offset:3072 sc1
    s_mov_b32 exec_lo, 0xff00ff
    s_mov_b32 exec_hi, 0xff00ff
    buffer_load_dword v152, v11, s[4:7], s59 offen sc1
    s_mov_b64 exec, -1
    v_lshrrev_b32 v155, 4, v1
    v_bfe_u32 v156, v1, 2, 2
    v_lshl_add_u32 v155, v155, 3, v156
    v_lshlrev_b32 v155, 7, v155
    v_and_b32 v156, 3, v1
    v_lshl_add_u32 v155, v156, 4, v155
    s_lshr_b32 vcc_lo, s60, 1
    s_lshl_b32 vcc_lo, vcc_lo, 14
    s_and_b32 vcc_hi, s60, 1
    s_lshl_b32 vcc_hi, vcc_hi, 6
    s_add_u32 vcc_lo, vcc_lo, vcc_hi
    s_add_u32 vcc_lo, vcc_lo, 98304
    v_add_u32 v155, vcc_lo, v155
    ds_read_b64_tr_b16 v[48:49], v155 offset:0
    ds_read_b64_tr_b16 v[50:51], v155 offset:512
    ds_read_b64_tr_b16 v[52:53], v155 offset:4096
    ds_read_b64_tr_b16 v[54:55], v155 offset:4608
    ds_read_b64_tr_b16 v[56:57], v155 offset:8192
    ds_read_b64_tr_b16 v[58:59], v155 offset:8704
    ds_read_b64_tr_b16 v[60:61], v155 offset:12288
    ds_read_b64_tr_b16 v[62:63], v155 offset:12800
    ds_read_b64_tr_b16 v[64:65], v155 offset:8
    ds_read_b64_tr_b16 v[66:67], v155 offset:520
    ds_read_b64_tr_b16 v[68:69], v155 offset:4104
    ds_read_b64_tr_b16 v[70:71], v155 offset:4616
    ds_read_b64_tr_b16 v[72:73], v155 offset:8200
    ds_read_b64_tr_b16 v[74:75], v155 offset:8712
    ds_read_b64_tr_b16 v[76:77], v155 offset:12296
    ds_read_b64_tr_b16 v[78:79], v155 offset:12808
    ds_read_b128 v[128:131], v12
    ds_read_b128 v[132:135], v12 offset:16
    ds_read_b32 v154, v13
    s_waitcnt lgkmcnt(0)
    v_lshlrev_b32 v136, 16, v128
    v_lshlrev_b32 v137, 16, v129
    v_lshlrev_b32 v138, 16, v130
    v_lshlrev_b32 v139, 16, v131
    v_lshlrev_b32 v140, 16, v132
    v_lshlrev_b32 v141, 16, v133
    v_lshlrev_b32 v142, 16, v134
    v_lshlrev_b32 v143, 16, v135
    s_waitcnt vmcnt(8)
    v_dot2_f32_bf16 v144, v80, v128, 0
    v_dot2_f32_bf16 v145, v80, v136, 0
    v_dot2_f32_bf16 v146, v81, v128, 0
    v_dot2_f32_bf16 v147, v81, v136, 0
    v_dot2_f32_bf16 v148, v82, v128, 0
    v_dot2_f32_bf16 v149, v82, v136, 0
    v_dot2_f32_bf16 v150, v83, v128, 0
    v_dot2_f32_bf16 v151, v83, v136, 0
    v_add3_u32 v153, v80, v81, v82
    v_add_u32 v153, v153, v83
    s_waitcnt vmcnt(7)
    v_dot2c_f32_bf16 v144, v84, v129
    v_dot2c_f32_bf16 v145, v84, v137
    v_dot2c_f32_bf16 v146, v85, v129
    v_dot2c_f32_bf16 v147, v85, v137
    v_dot2c_f32_bf16 v148, v86, v129
    v_dot2c_f32_bf16 v149, v86, v137
    v_dot2c_f32_bf16 v150, v87, v129
    v_dot2c_f32_bf16 v151, v87, v137
    v_add3_u32 v153, v153, v84, v85
    v_add3_u32 v153, v153, v86, v87
    s_waitcnt vmcnt(6)
    v_dot2c_f32_bf16 v144, v88, v130
    v_dot2c_f32_bf16 v145, v88, v138
    v_dot2c_f32_bf16 v146, v89, v130
    v_dot2c_f32_bf16 v147, v89, v138
    v_dot2c_f32_bf16 v148, v90, v130
    v_dot2c_f32_bf16 v149, v90, v138
    v_dot2c_f32_bf16 v150, v91, v130
    v_dot2c_f32_bf16 v151, v91, v138
    v_add3_u32 v153, v153, v88, v89
    v_add3_u32 v153, v153, v90, v91
    s_waitcnt vmcnt(5)
    v_dot2c_f32_bf16 v144, v92, v131
    v_dot2c_f32_bf16 v145, v92, v139
    v_dot2c_f32_bf16 v146, v93, v131
    v_dot2c_f32_bf16 v147, v93, v139
    v_dot2c_f32_bf16 v148, v94, v131
    v_dot2c_f32_bf16 v149, v94, v139
    v_dot2c_f32_bf16 v150, v95, v131
    v_dot2c_f32_bf16 v151, v95, v139
    v_add3_u32 v153, v153, v92, v93
    v_add3_u32 v153, v153, v94, v95
    s_waitcnt vmcnt(4)
    v_dot2c_f32_bf16 v144, v96, v132
    v_dot2c_f32_bf16 v145, v96, v140
    v_dot2c_f32_bf16 v146, v97, v132
    v_dot2c_f32_bf16 v147, v97, v140
    v_dot2c_f32_bf16 v148, v98, v132
    v_dot2c_f32_bf16 v149, v98, v140
    v_dot2c_f32_bf16 v150, v99, v132
    v_dot2c_f32_bf16 v151, v99, v140
    v_add3_u32 v153, v153, v96, v97
    v_add3_u32 v153, v153, v98, v99
    s_waitcnt vmcnt(3)
    v_dot2c_f32_bf16 v144, v100, v133
    v_dot2c_f32_bf16 v145, v100, v141
    v_dot2c_f32_bf16 v146, v101, v133
    v_dot2c_f32_bf16 v147, v101, v141
    v_dot2c_f32_bf16 v148, v102, v133
    v_dot2c_f32_bf16 v149, v102, v141
    v_dot2c_f32_bf16 v150, v103, v133
    v_dot2c_f32_bf16 v151, v103, v141
    v_add3_u32 v153, v153, v100, v101
    v_add3_u32 v153, v153, v102, v103
    s_waitcnt vmcnt(2)
    v_dot2c_f32_bf16 v144, v104, v134
    v_dot2c_f32_bf16 v145, v104, v142
    v_dot2c_f32_bf16 v146, v105, v134
    v_dot2c_f32_bf16 v147, v105, v142
    v_dot2c_f32_bf16 v148, v106, v134
    v_dot2c_f32_bf16 v149, v106, v142
    v_dot2c_f32_bf16 v150, v107, v134
    v_dot2c_f32_bf16 v151, v107, v142
    v_add3_u32 v153, v153, v104, v105
    v_add3_u32 v153, v153, v106, v107
    s_waitcnt vmcnt(1)
    v_dot2c_f32_bf16 v144, v108, v135
    v_dot2c_f32_bf16 v145, v108, v143
    v_dot2c_f32_bf16 v146, v109, v135
    v_dot2c_f32_bf16 v147, v109, v143
    v_dot2c_f32_bf16 v148, v110, v135
    v_dot2c_f32_bf16 v149, v110, v143
    v_dot2c_f32_bf16 v150, v111, v135
    v_dot2c_f32_bf16 v151, v111, v143
    v_add3_u32 v153, v153, v108, v109
    v_add3_u32 v153, v153, v110, v111
    s_waitcnt vmcnt(0)
    v_sub_u32 v153, v153, v152
    v_mul_f32 v144, v144, v154
    v_mul_f32 v145, v145, v154
    v_add_u32_dpp v153, v153, v153 row_ror:1 row_mask:0xf bank_mask:0xf
    v_mul_f32 v146, v146, v154
    v_mul_f32 v147, v147, v154
    v_add_u32_dpp v153, v153, v153 row_ror:2 row_mask:0xf bank_mask:0xf
    v_mul_f32 v148, v148, v154
    v_mul_f32 v149, v149, v154
    v_add_u32_dpp v153, v153, v153 row_ror:4 row_mask:0xf bank_mask:0xf
    v_mul_f32 v150, v150, v154
    v_mul_f32 v151, v151, v154
    v_add_u32_dpp v153, v153, v153 row_ror:8 row_mask:0xf bank_mask:0xf
    v_cvt_pk_bf16_f32 v120, v144, v145
    v_cvt_pk_bf16_f32 v121, v146, v147
    v_cvt_pk_bf16_f32 v122, v148, v149
    v_cvt_pk_bf16_f32 v123, v150, v151
    v_cmp_ne_u32 vcc, s56, v153
    s_cbranch_vccz O_61
P_62:
    buffer_load_dwordx4 v[80:83], v2, s[4:7], s3 offen offset:0 sc1
    buffer_load_dwordx4 v[84:87], v2, s[4:7], s3 offen offset:1024 sc1
    buffer_load_dwordx4 v[88:91], v2, s[4:7], s3 offen offset:2048 sc1
    buffer_load_dwordx4 v[92:95], v2, s[4:7], s3 offen offset:3072 sc1
    buffer_load_dwordx4 v[96:99], v2, s[4:7], s69 offen offset:0 sc1
    buffer_load_dwordx4 v[100:103], v2, s[4:7], s69 offen offset:1024 sc1
    buffer_load_dwordx4 v[104:107], v2, s[4:7], s69 offen offset:2048 sc1
    buffer_load_dwordx4 v[108:111], v2, s[4:7], s69 offen offset:3072 sc1
    s_mov_b32 exec_lo, 0xff00ff
    s_mov_b32 exec_hi, 0xff00ff
    buffer_load_dword v152, v11, s[4:7], s59 offen sc1
    s_mov_b64 exec, -1
    ds_read_b128 v[128:131], v12
    ds_read_b128 v[132:135], v12 offset:16
    ds_read_b32 v154, v13
    s_waitcnt lgkmcnt(0)
    v_lshlrev_b32 v136, 16, v128
    v_lshlrev_b32 v137, 16, v129
    v_lshlrev_b32 v138, 16, v130
    v_lshlrev_b32 v139, 16, v131
    v_lshlrev_b32 v140, 16, v132
    v_lshlrev_b32 v141, 16, v133
    v_lshlrev_b32 v142, 16, v134
    v_lshlrev_b32 v143, 16, v135
    s_waitcnt vmcnt(8)
    v_dot2_f32_bf16 v144, v80, v128, 0
    v_dot2_f32_bf16 v145, v80, v136, 0
    v_dot2_f32_bf16 v146, v81, v128, 0
    v_dot2_f32_bf16 v147, v81, v136, 0
    v_dot2_f32_bf16 v148, v82, v128, 0
    v_dot2_f32_bf16 v149, v82, v136, 0
    v_dot2_f32_bf16 v150, v83, v128, 0
    v_dot2_f32_bf16 v151, v83, v136, 0
    v_add3_u32 v153, v80, v81, v82
    v_add_u32 v153, v153, v83
    s_waitcnt vmcnt(7)
    v_dot2c_f32_bf16 v144, v84, v129
    v_dot2c_f32_bf16 v145, v84, v137
    v_dot2c_f32_bf16 v146, v85, v129
    v_dot2c_f32_bf16 v147, v85, v137
    v_dot2c_f32_bf16 v148, v86, v129
    v_dot2c_f32_bf16 v149, v86, v137
    v_dot2c_f32_bf16 v150, v87, v129
    v_dot2c_f32_bf16 v151, v87, v137
    v_add3_u32 v153, v153, v84, v85
    v_add3_u32 v153, v153, v86, v87
    s_waitcnt vmcnt(6)
    v_dot2c_f32_bf16 v144, v88, v130
    v_dot2c_f32_bf16 v145, v88, v138
    v_dot2c_f32_bf16 v146, v89, v130
    v_dot2c_f32_bf16 v147, v89, v138
    v_dot2c_f32_bf16 v148, v90, v130
    v_dot2c_f32_bf16 v149, v90, v138
    v_dot2c_f32_bf16 v150, v91, v130
    v_dot2c_f32_bf16 v151, v91, v138
    v_add3_u32 v153, v153, v88, v89
    v_add3_u32 v153, v153, v90, v91
    s_waitcnt vmcnt(5)
    v_dot2c_f32_bf16 v144, v92, v131
    v_dot2c_f32_bf16 v145, v92, v139
    v_dot2c_f32_bf16 v146, v93, v131
    v_dot2c_f32_bf16 v147, v93, v139
    v_dot2c_f32_bf16 v148, v94, v131
    v_dot2c_f32_bf16 v149, v94, v139
    v_dot2c_f32_bf16 v150, v95, v131
    v_dot2c_f32_bf16 v151, v95, v139
    v_add3_u32 v153, v153, v92, v93
    v_add3_u32 v153, v153, v94, v95
    s_waitcnt vmcnt(4)
    v_dot2c_f32_bf16 v144, v96, v132
    v_dot2c_f32_bf16 v145, v96, v140
    v_dot2c_f32_bf16 v146, v97, v132
    v_dot2c_f32_bf16 v147, v97, v140
    v_dot2c_f32_bf16 v148, v98, v132
    v_dot2c_f32_bf16 v149, v98, v140
    v_dot2c_f32_bf16 v150, v99, v132
    v_dot2c_f32_bf16 v151, v99, v140
    v_add3_u32 v153, v153, v96, v97
    v_add3_u32 v153, v153, v98, v99
    s_waitcnt vmcnt(3)
    v_dot2c_f32_bf16 v144, v100, v133
    v_dot2c_f32_bf16 v145, v100, v141
    v_dot2c_f32_bf16 v146, v101, v133
    v_dot2c_f32_bf16 v147, v101, v141
    v_dot2c_f32_bf16 v148, v102, v133
    v_dot2c_f32_bf16 v149, v102, v141
    v_dot2c_f32_bf16 v150, v103, v133
    v_dot2c_f32_bf16 v151, v103, v141
    v_add3_u32 v153, v153, v100, v101
    v_add3_u32 v153, v153, v102, v103
    s_waitcnt vmcnt(2)
    v_dot2c_f32_bf16 v144, v104, v134
    v_dot2c_f32_bf16 v145, v104, v142
    v_dot2c_f32_bf16 v146, v105, v134
    v_dot2c_f32_bf16 v147, v105, v142
    v_dot2c_f32_bf16 v148, v106, v134
    v_dot2c_f32_bf16 v149, v106, v142
    v_dot2c_f32_bf16 v150, v107, v134
    v_dot2c_f32_bf16 v151, v107, v142
    v_add3_u32 v153, v153, v104, v105
    v_add3_u32 v153, v153, v106, v107
    s_waitcnt vmcnt(1)
    v_dot2c_f32_bf16 v144, v108, v135
    v_dot2c_f32_bf16 v145, v108, v143
    v_dot2c_f32_bf16 v146, v109, v135
    v_dot2c_f32_bf16 v147, v109, v143
    v_dot2c_f32_bf16 v148, v110, v135
    v_dot2c_f32_bf16 v149, v110, v143
    v_dot2c_f32_bf16 v150, v111, v135
    v_dot2c_f32_bf16 v151, v111, v143
    v_add3_u32 v153, v153, v108, v109
    v_add3_u32 v153, v153, v110, v111
    s_waitcnt vmcnt(0)
    v_sub_u32 v153, v153, v152
    v_mul_f32 v144, v144, v154
    v_mul_f32 v145, v145, v154
    v_add_u32_dpp v153, v153, v153 row_ror:1 row_mask:0xf bank_mask:0xf
    v_mul_f32 v146, v146, v154
    v_mul_f32 v147, v147, v154
    v_add_u32_dpp v153, v153, v153 row_ror:2 row_mask:0xf bank_mask:0xf
    v_mul_f32 v148, v148, v154
    v_mul_f32 v149, v149, v154
    v_add_u32_dpp v153, v153, v153 row_ror:4 row_mask:0xf bank_mask:0xf
    v_mul_f32 v150, v150, v154
    v_mul_f32 v151, v151, v154
    v_add_u32_dpp v153, v153, v153 row_ror:8 row_mask:0xf bank_mask:0xf
    v_cvt_pk_bf16_f32 v120, v144, v145
    v_cvt_pk_bf16_f32 v121, v146, v147
    v_cvt_pk_bf16_f32 v122, v148, v149
    v_cvt_pk_bf16_f32 v123, v150, v151
    v_cmp_ne_u32 vcc, s56, v153
    s_cbranch_vccz Q_63
    s_add_u32 s64, s64, 1
    s_cmp_gt_u32 s64, 200000
    s_cbranch_scc1 Q_63
    s_sleep 1
    s_branch P_62
Q_63:
O_61:
    ds_write_b128 v14, v[120:123]
    s_lshl_b32 s3, s66, 13
    s_lshl_b32 s69, s60, 11
    s_add_u32 s3, s3, s69
    s_lshl_b32 s69, s67, 9
    s_add_u32 s3, s3, s69
    s_add_u32 s3, s3, 0x80000
    s_waitcnt lgkmcnt(0)
    s_barrier
    ds_read_b128 v[80:83], v15 offset:0
    ds_read_b128 v[84:87], v15 offset:64
    ds_read_b128 v[88:91], v15 offset:128
    ds_read_b128 v[92:95], v15 offset:192
    s_and_b32 s69, s62, 1
    s_lshl_b32 s56, s61, 1
    s_add_u32 s69, s69, s56
    s_lshl_b32 s69, s69, 1
    s_lshr_b32 s56, s60, 1
    s_add_u32 s69, s69, s56
    s_lshl_b32 s69, s69, 13
    s_add_u32 s69, s69, 0x80000
    v_bfe_u32 v156, v1, 2, 1
    v_cmp_eq_u32 vcc, 0, v156
    v_lshl_add_u32 v156, v156, 8, v6
    v_mov_b32 v157, s63
    s_waitcnt lgkmcnt(0)
    v_mfma_f32_16x16x32_bf16 v[112:115], v[16:19], v[80:83], 0
    v_mfma_f32_16x16x32_bf16 v[116:119], v[32:35], v[80:83], 0
    v_mfma_f32_16x16x32_bf16 v[112:115], v[20:23], v[84:87], v[112:115]
    v_mfma_f32_16x16x32_bf16 v[116:119], v[36:39], v[84:87], v[116:119]
    v_mfma_f32_16x16x32_bf16 v[112:115], v[24:27], v[88:91], v[112:115]
    v_mfma_f32_16x16x32_bf16 v[116:119], v[40:43], v[88:91], v[116:119]
    v_mfma_f32_16x16x32_bf16 v[112:115], v[28:31], v[92:95], v[112:115]
    v_mfma_f32_16x16x32_bf16 v[116:119], v[44:47], v[92:95], v[116:119]
    s_nop 6
    v_add_f32_dpp v112, v112, v112 row_ror:4 row_mask:0xf bank_mask:0xf
    v_add_f32_dpp v113, v113, v113 row_ror:4 row_mask:0xf bank_mask:0xf
    v_add_f32_dpp v114, v114, v114 row_ror:4 row_mask:0xf bank_mask:0xf
    v_add_f32_dpp v115, v115, v115 row_ror:4 row_mask:0xf bank_mask:0xf
    v_add_f32_dpp v116, v116, v116 row_ror:4 row_mask:0xf bank_mask:0xf
    v_add_f32_dpp v117, v117, v117 row_ror:4 row_mask:0xf bank_mask:0xf
    v_add_f32_dpp v118, v118, v118 row_ror:4 row_mask:0xf bank_mask:0xf
    v_add_f32_dpp v119, v119, v119 row_ror:4 row_mask:0xf bank_mask:0xf
    v_add_f32_dpp v112, v112, v112 row_ror:8 row_mask:0xf bank_mask:0xf
    v_add_f32_dpp v113, v113, v113 row_ror:8 row_mask:0xf bank_mask:0xf
    v_add_f32_dpp v114, v114, v114 row_ror:8 row_mask:0xf bank_mask:0xf
    v_add_f32_dpp v115, v115, v115 row_ror:8 row_mask:0xf bank_mask:0xf
    v_add_f32_dpp v116, v116, v116 row_ror:8 row_mask:0xf bank_mask:0xf
    v_add_f32_dpp v117, v117, v117 row_ror:8 row_mask:0xf bank_mask:0xf
    v_add_f32_dpp v118, v118, v118 row_ror:8 row_mask:0xf bank_mask:0xf
    v_add_f32_dpp v119, v119, v119 row_ror:8 row_mask:0xf bank_mask:0xf
    v_cvt_pk_bf16_f32 v96, v112, v113
    v_cvt_pk_bf16_f32 v97, v114, v115
    v_cvt_pk_bf16_f32 v98, v116, v117
    v_cvt_pk_bf16_f32 v99, v118, v119
    v_mov_b32 v120, v98
    v_cndmask_b32 v121, v99, v157, vcc
    v_cndmask_b32 v122, v157, v96, vcc
    v_mov_b32 v123, v97
    s_mov_b32 exec_lo, 0xff00ff
    s_mov_b32 exec_hi, 0xff00ff
    s_cmp_eq_u32 s65, 0
    s_cbranch_scc1 G_64
    buffer_store_dwordx4 v[120:123], v156, s[4:7], s3 offen
    s_branch G_65
G_64:
    buffer_store_dwordx4 v[120:123], v156, s[4:7], s3 offen sc1
G_65:
    s_mov_b64 exec, -1
    s_add_u32 s56, s69, 4096
    v_and_b32 v13, 3, v1
    v_lshrrev_b32 v11, 4, v1
    v_lshl_add_u32 v11, v13, 2, v11
    v_lshlrev_b32 v11, 5, v11
    v_add_u32 v11, 156672, v11
    s_lshl_b32 vcc_lo, s60, 9
    v_add_u32 v12, vcc_lo, v11
    v_bfe_u32 v14, v1, 3, 2
    v_lshl_add_u32 v11, v14, 2, v13
    v_lshlrev_b32 v11, 5, v11
    v_bfe_u32 v15, v1, 2, 1
    v_lshl_add_u32 v11, v15, 9, v11
    v_add_u32 v11, 156672, v11
    v_lshlrev_b32 v14, 10, v14
    v_and_b32 v15, 7, v1
    v_lshl_add_u32 v14, v15, 4, v14
    s_lshl_b32 s3, s61, 1
    s_and_b32 s59, s51, 1
    s_add_u32 s3, s3, s59
    s_lshl_b32 s3, s3, 12
    s_lshr_b32 s59, s51, 1
    s_lshl_b32 s59, s59, 7
    s_add_u32 s3, s3, s59
    s_add_u32 s3, s3, 0x150000
P_66:
    buffer_load_dwordx4 v[80:83], v4, s[4:7], s69 offen offset:0 sc1
    buffer_load_dwordx4 v[84:87], v4, s[4:7], s69 offen offset:256 sc1
    buffer_load_dwordx4 v[88:91], v4, s[4:7], s69 offen offset:2048 sc1
    buffer_load_dwordx4 v[92:95], v4, s[4:7], s69 offen offset:2304 sc1
    buffer_load_dwordx4 v[96:99], v4, s[4:7], s56 offen offset:0 sc1
    buffer_load_dwordx4 v[100:103], v4, s[4:7], s56 offen offset:256 sc1
    buffer_load_dwordx4 v[104:107], v4, s[4:7], s56 offen offset:2048 sc1
    buffer_load_dwordx4 v[108:111], v4, s[4:7], s56 offen offset:2304 sc1
    s_waitcnt vmcnt(6)
    v_xor_b32 v10, s63, v81
    v_bitop3_b32 v10, v10, v86, s63 bitop3:0xf6
    s_waitcnt vmcnt(4)
    v_bitop3_b32 v10, v10, v89, s63 bitop3:0xf6
    v_bitop3_b32 v10, v10, v94, s63 bitop3:0xf6
    s_waitcnt vmcnt(2)
    v_bitop3_b32 v10, v10, v97, s63 bitop3:0xf6
    v_bitop3_b32 v10, v10, v102, s63 bitop3:0xf6
    s_waitcnt vmcnt(0)
    v_bitop3_b32 v10, v10, v105, s63 bitop3:0xf6
    v_bitop3_b32 v10, v10, v110, s63 bitop3:0xf6
    v_cmp_ne_u32 vcc, 0, v10
    s_cbranch_vccz Q_67
    s_add_u32 s64, s64, 1
    s_cmp_gt_u32 s64, 200000
    s_cbranch_scc1 Q_67
    s_branch P_66
Q_67:
    s_or_b32 vcc_lo, s62, s60
    s_cmp_lg_u32 vcc_lo, 0
    s_cbranch_scc1 C_68
    s_lshl_b32 vcc_lo, s61, 7
    s_add_u32 vcc_lo, vcc_lo, 0x1c00
    v_mov_b32 v156, vcc_lo
    v_mov_b32 v157, s63
    s_mov_b64 exec, 1
    buffer_store_dword v157, v156, s[4:7], 0 offen sc1
    s_mov_b64 exec, -1
C_68:
    s_waitcnt lgkmcnt(0)
    v_mfma_f32_16x16x32_bf16 v[112:115], v[48:51], v[82:85], 0
    v_mfma_f32_16x16x32_bf16 v[116:119], v[64:67], v[82:85], 0
    v_mfma_f32_16x16x32_bf16 v[112:115], v[52:55], v[90:93], v[112:115]
    v_mfma_f32_16x16x32_bf16 v[116:119], v[68:71], v[90:93], v[116:119]
    v_mfma_f32_16x16x32_bf16 v[112:115], v[56:59], v[98:101], v[112:115]
    v_mfma_f32_16x16x32_bf16 v[116:119], v[72:75], v[98:101], v[116:119]
    v_mfma_f32_16x16x32_bf16 v[112:115], v[60:63], v[106:109], v[112:115]
    v_mfma_f32_16x16x32_bf16 v[116:119], v[76:79], v[106:109], v[116:119]
    s_nop 6
    v_add_f32_dpp v112, v112, v112 row_ror:4 row_mask:0xf bank_mask:0xf
    v_add_f32_dpp v113, v113, v113 row_ror:4 row_mask:0xf bank_mask:0xf
    v_add_f32_dpp v114, v114, v114 row_ror:4 row_mask:0xf bank_mask:0xf
    v_add_f32_dpp v115, v115, v115 row_ror:4 row_mask:0xf bank_mask:0xf
    v_add_f32_dpp v116, v116, v116 row_ror:4 row_mask:0xf bank_mask:0xf
    v_add_f32_dpp v117, v117, v117 row_ror:4 row_mask:0xf bank_mask:0xf
    v_add_f32_dpp v118, v118, v118 row_ror:4 row_mask:0xf bank_mask:0xf
    v_add_f32_dpp v119, v119, v119 row_ror:4 row_mask:0xf bank_mask:0xf
    v_add_f32_dpp v112, v112, v112 row_ror:8 row_mask:0xf bank_mask:0xf
    v_add_f32_dpp v113, v113, v113 row_ror:8 row_mask:0xf bank_mask:0xf
    v_add_f32_dpp v114, v114, v114 row_ror:8 row_mask:0xf bank_mask:0xf
    v_add_f32_dpp v115, v115, v115 row_ror:8 row_mask:0xf bank_mask:0xf
    v_add_f32_dpp v116, v116, v116 row_ror:8 row_mask:0xf bank_mask:0xf
    v_add_f32_dpp v117, v117, v117 row_ror:8 row_mask:0xf bank_mask:0xf
    v_add_f32_dpp v118, v118, v118 row_ror:8 row_mask:0xf bank_mask:0xf
    v_add_f32_dpp v119, v119, v119 row_ror:8 row_mask:0xf bank_mask:0xf
    s_mov_b32 exec_lo, 0xf000f
    s_mov_b32 exec_hi, 0xf000f
    ds_write_b128 v12, v[112:115]
    ds_write_b128 v12, v[116:119] offset:16
    s_waitcnt lgkmcnt(0)
    s_barrier
    s_cmp_lg_u32 s60, 0
    s_cbranch_scc1 F_69
    s_mov_b32 exec_lo, 0xffffffff
    s_mov_b32 exec_hi, 0x0
    ds_read_b128 v[80:83], v11 offset:0
    ds_read_b128 v[84:87], v11 offset:16
    ds_read_b128 v[88:91], v11 offset:1024
    ds_read_b128 v[92:95], v11 offset:1040
    s_waitcnt lgkmcnt(0)
    v_pk_add_f32 v[112:113], v[80:81], v[88:89]
    v_pk_add_f32 v[114:115], v[82:83], v[90:91]
    v_pk_add_f32 v[116:117], v[84:85], v[92:93]
    v_pk_add_f32 v[118:119], v[86:87], v[94:95]
    v_cvt_pk_bf16_f32 v120, v112, v113
    v_cvt_pk_bf16_f32 v121, v114, v115
    v_cvt_pk_bf16_f32 v122, v116, v117
    v_cvt_pk_bf16_f32 v123, v118, v119
    v_min_u32 v123, -2, v123
    buffer_store_dwordx4 v[120:123], v14, s[4:7], s3 offen sc1
F_69:
L_Fend:
    s_endpgm
L_FH:
    s_getreg_b32 s65, hwreg(HW_REG_XCC_ID, 0, 4)
    v_mov_b32 v120, -1
    v_mov_b32 v121, -1
    v_mov_b32 v122, -1
    v_mov_b32 v123, -1
    s_lshl_b32 s3, s67, 14
    s_lshl_b32 s69, s66, 7
    s_add_u32 s3, s3, s69
    s_add_u32 s3, s3, 0x140000
    v_lshrrev_b32 v12, 3, v1
    v_lshlrev_b32 v12, 12, v12
    v_and_b32 v13, 7, v1
    v_lshl_add_u32 v12, v13, 4, v12
    v_add_u32 v12, s3, v12
    s_lshl_b32 s3, s61, 1
    s_and_b32 s69, s51, 1
    s_add_u32 s3, s3, s69
    s_lshl_b32 s3, s3, 12
    s_lshr_b32 s69, s51, 1
    s_lshl_b32 s69, s69, 7
    s_add_u32 s3, s3, s69
    s_add_u32 s3, s3, 0x150000
    v_bfe_u32 v10, v1, 3, 2
    v_lshlrev_b32 v10, 10, v10
    v_lshl_add_u32 v10, v13, 4, v10
    v_add_u32 v10, s3, v10
    v_cmp_gt_u32 vcc, 32, v1
    s_nop 1
    v_cndmask_b32 v12, v10, v12, vcc
    buffer_store_dwordx4 v[120:123], v12, s[4:7], 0 offen sc1
    s_waitcnt lgkmcnt(0)
    s_mul_i32 s63, s63, 0x9E3779B1
    s_add_u32 s63, s63, 0x7F4A7C15
    s_lshl_b32 s58, s68, 7
    s_add_u32 s58, s58, 0x10000
    v_mov_b32 v14, s63
    v_mov_b32 v15, s65
    s_mov_b64 exec, 1
    buffer_store_dwordx2 v[14:15], v2, s[4:7], s58 offen sc1
    s_mov_b64 exec, 0xffffffff
    v_bfe_u32 v10, v1, 4, 1
    v_lshlrev_b32 v10, 18, v10
    v_bfe_u32 v11, v1, 2, 2
    v_lshl_add_u32 v10, v11, 11, v10
    v_and_b32 v11, 3, v1
    v_lshl_add_u32 v10, v11, 7, v10
    s_lshl_b32 s3, s66, 13
    s_lshl_b32 s69, s67, 9
    s_add_u32 s3, s3, s69
    s_add_u32 s3, s3, 0x40000
    buffer_load_dword v12, v10, s[4:7], s3 offen sc1
    s_barrier
    s_barrier
    s_barrier
    s_waitcnt vmcnt(0)
    s_barrier
    s_endpgm
L_end:
    s_endpgm
.section .rodata,"a"
.p2align 6
.amdhsa_kernel adaLN_cond__compressed_kv_cla__glu_gated_glu__decode_kernel
  .amdhsa_next_free_vgpr 256
  .amdhsa_next_free_sgpr 102
  .amdhsa_accum_offset 256
  .amdhsa_group_segment_fixed_size 0
  .amdhsa_kernarg_size 120
  .amdhsa_user_sgpr_count 2
  .amdhsa_user_sgpr_kernarg_segment_ptr 1
  .amdhsa_system_sgpr_workgroup_id_x 1
  .amdhsa_float_denorm_mode_32 3
.end_amdhsa_kernel
```
